```python
import torch

def _softmax(x, axis=-1):
    return torch.softmax(x, dim=axis)

def _gelu(x):
    return torch.nn.functional.gelu(x, approximate='tanh')

def _silu(x):
    return torch.nn.functional.silu(x)

def _sigmoid(x):
    return torch.sigmoid(x)

def _layernorm(x, axis=-1, eps=1e-05):
    m = x.mean(dim=axis, keepdim=True)
    v = x.var(dim=axis, keepdim=True, unbiased=False)
    return (x - m) / torch.sqrt(v + eps)

def _scatter_add(tgt, idx, src, axis=0):
    return tgt.clone().index_add_(axis, idx, src)

def _segment_sum(src, seg, n):
    out = torch.zeros((n,) + src.shape[1:], dtype=src.dtype)
    return out.index_add_(0, seg, src)

def _pad(x, pw):
    flat = tuple((v for pair in reversed(pw) for v in pair))
    return torch.nn.functional.pad(x, flat)
kernel_name = 'adaLN_cond__gqa_block_cached__mixer_channel_mlp__decode'

def setup_inputs():

    _w = lambda a: (lambda t: t.to(torch.bfloat16) if t.is_floating_point() else t)(torch.as_tensor(a))

    def _A_setup():
        B, Sq, D = (1, 1, 1024)
        Hq, Hkv, Sk, Dh = (32, 4, 65536, 128)
        assert Hq % Hkv == 0, (Hq, Hkv)
        return {'x': _w((lambda *s: torch.randn(*s, dtype=torch.bfloat16) * 0.1)(B, Sq, D)), 'k_cache': _w((lambda *s: torch.randn(*s, dtype=torch.bfloat16) * 0.8)(B, Hkv, Sk, Dh)), 'v_cache': _w((lambda *s: torch.randn(*s, dtype=torch.bfloat16) * 0.8)(B, Hkv, Sk, Dh)), 'wq': _w((lambda *s: torch.randn(*s, dtype=torch.bfloat16) * 0.8)(D, Hq * Dh) * D ** (-0.5)), 'wo': _w((lambda *s: torch.randn(*s, dtype=torch.bfloat16) * 0.8)(Hq * Dh, D) * (Hq * Dh) ** (-0.5))}
    _A_in = _A_setup()

    def _B_setup():
        B, S, D, F = (1, 1, 1024, 3584)
        return {'x': _w((lambda *s: torch.randn(*s, dtype=torch.bfloat16) * 0.1)(B, S, D)), 'w1': _w((lambda *s: torch.randn(*s, dtype=torch.bfloat16) * 3.2)(D, F) * D ** (-0.5)), 'b1': _w((lambda *s: torch.randn(*s, dtype=torch.bfloat16) * 3.2)(F)), 'w2': _w((lambda *s: torch.randn(*s, dtype=torch.bfloat16) * 3.2)(F, D) * F ** (-0.5)), 'b2': _w((lambda *s: torch.randn(*s, dtype=torch.bfloat16) * 3.2)(D))}
    _B_in = _B_setup()
    return {'A_x': _A_in['x'], 'A_k_cache': _A_in['k_cache'], 'A_v_cache': _A_in['v_cache'], 'A_wq': _A_in['wq'], 'A_wo': _A_in['wo'], 'B_x': _B_in['x'], 'B_w1': _B_in['w1'], 'B_b1': _B_in['b1'], 'B_w2': _B_in['w2'], 'B_b2': _B_in['b2'], 'c': _w((lambda *s: torch.randn(*s, dtype=torch.bfloat16) * 0.4)(1, 1024) * 8.0), 'w_mod': _w((lambda *s: torch.randn(*s, dtype=torch.bfloat16) * 0.4)(1024, 6 * 1024) * 1024 ** (-0.5) * 8.0)}

def reference(A_x, A_k_cache, A_v_cache, A_wq, A_wo, B_x, B_w1, B_b1, B_w2, B_b2, c, w_mod):

    def _A_ref(x, k_cache, v_cache, wq, wo):
        B, Sq, D = x.shape
        Hq, Dh = (32, 128)
        Hkv = k_cache.shape[1]
        rep = Hq // Hkv
        q = (lambda x, *d: x.permute(*d))((x @ wq).reshape(B, Sq, Hq, Dh), 0, 2, 1, 3)
        k = (lambda x, n, axis: torch.repeat_interleave(x, n, dim=axis))(k_cache, rep, axis=1)
        v = (lambda x, n, axis: torch.repeat_interleave(x, n, dim=axis))(v_cache, rep, axis=1)
        scores = torch.einsum('bhqd,bhkd->bhqk', q, k) * Dh ** (-0.5)
        p = _softmax(scores, axis=-1)
        o = torch.einsum('bhqk,bhkd->bhqd', p, v)
        return (lambda x, *d: x.permute(*d))(o, 0, 2, 1, 3).reshape(B, Sq, Hq * Dh) @ wo

    def _B_ref(x, w1, b1, w2, b2):
        y = _layernorm(x, axis=-1)
        h = _gelu(torch.einsum('bsd,df->bsf', y, w1) + b1)
        return torch.einsum('bsf,fd->bsd', h, w2) + b2
    x = A_x
    mod = (_silu(c) @ w_mod).reshape(c.shape[0], 6, 1, -1)
    sa, ca, ga, sb, cb, gb = (mod[:, 0].clone(), mod[:, 1].clone(), mod[:, 2].clone(), mod[:, 3].clone(), mod[:, 4].clone(), mod[:, 5].clone())
    h = _layernorm(x, axis=-1) * (1 + ca) + sa
    x = x + ga * _A_ref(h, A_k_cache, A_v_cache, A_wq, A_wo)
    h = _layernorm(x, axis=-1) * (1 + cb) + sb
    x = x + gb * _B_ref(h, B_w1, B_b1, B_w2, B_b2)
    return x
```

```asm
; @launch grid=(256,1,1) block=(768,1,1) lds=140288
.amdgcn_target "amdgcn-amd-amdhsa--gfx950"
.text
.globl adaLN_cond__gqa_block_cached__mixer_channel_mlp__decode_kernel
.p2align 8
.type adaLN_cond__gqa_block_cached__mixer_channel_mlp__decode_kernel,@function
adaLN_cond__gqa_block_cached__mixer_channel_mlp__decode_kernel:
  s_cmp_ge_u32 s2, 256
  s_cbranch_scc1 L_end
  s_load_dwordx16 s[16:31], s[0:1], 0
  s_load_dwordx8 s[32:39], s[0:1], 64
  s_load_dwordx4 s[40:43], s[0:1], 96
  s_load_dwordx2 s[44:45], s[0:1], 112
  s_getpc_b64 s[4:5]
L_pc0:
  v_lshlrev_b32 v1, 6, v0
  v_min_u32 v1, L_codeend-L_pc0-4, v1
  global_load_dword v100, v1, s[4:5]
  v_lshrrev_b32 v1, 6, v0
  v_and_b32 v0, 63, v0
  v_readfirstlane_b32 s3, v1
  s_nop 0
  s_cmp_ge_u32 s3, 4
  s_cbranch_scc1 L_stream
  s_setprio 3
  v_lshrrev_b32 v1, 3, v0
  v_and_b32 v2, 7, v0
  v_lshlrev_b32 v2, 4, v2
  v_lshlrev_b32 v4, 2, v0
  v_mul_u32_u24 v165, 49152, v1
  v_add_u32 v165, v165, v2
  v_lshlrev_b32 v166, 3, v1
  s_lshr_b32 s4, s2, 5
  s_lshl_b32 s4, s4, 7
  s_lshl_b32 s14, s3, 5
  s_add_u32 s4, s4, s14
  s_lshl_b32 s15, s4, 1
  s_mul_i32 s4, s4, 12288
  s_and_b32 s14, s2, 31
  s_lshl_b32 s14, s14, 7
  s_add_u32 s4, s4, s14
  v_mov_b32 v8, 0
  ds_write_b32 v4, v8 offset:0
  s_waitcnt lgkmcnt(0)
  s_mov_b32 s52, s38
  s_mov_b32 s53, s39
  s_mov_b32 s54, 0xc00000
  s_mov_b32 s55, 0x20000
  s_mov_b32 s60, s36
  s_mov_b32 s61, s37
  s_mov_b32 s62, 0x800
  s_mov_b32 s63, 0x20000
  buffer_load_dwordx4 v[20:23], v165, s[52:55], s4 offen nt
  s_add_u32 s4, s4, 12288
  buffer_load_dwordx4 v[24:27], v165, s[52:55], s4 offen nt
  s_add_u32 s4, s4, 12288
  buffer_load_dwordx4 v[28:31], v165, s[52:55], s4 offen nt
  s_add_u32 s4, s4, 12288
  buffer_load_dwordx4 v[32:35], v165, s[52:55], s4 offen nt
  buffer_load_dwordx2 v[160:161], v166, s[60:63], s15 offen
  s_mov_b32 s48, s44
  s_mov_b32 s49, s45
  s_mov_b32 s50, 0x10000000
  s_mov_b32 s51, 0x20000
  s_lshr_b32 s5, s2, 6
  s_and_b32 s6, s2, 63
  v_lshlrev_b32 v5, 4, v0
  s_lshl_b32 s4, s5, 2
  s_add_u32 s4, s4, s3
  s_lshl_b32 s84, s4, 11
  s_add_u32 s85, s84, 32768
  s_and_b32 s4, s2, 31
  s_lshl_b32 s4, s4, 3
  s_lshr_b32 s14, s2, 5
  s_add_u32 s4, s4, s14
  s_lshl_b32 s10, s4, 8
  buffer_load_dword v6, v4, s[48:51], s10 offen sc1
  buffer_load_dwordx4 v[52:55], v5, s[48:51], s84 offen offset:0 sc1
  buffer_load_dwordx4 v[56:59], v5, s[48:51], s84 offen offset:1024 sc1
  buffer_load_dwordx4 v[60:63], v5, s[48:51], s85 offen offset:0 sc1
  buffer_load_dwordx4 v[64:67], v5, s[48:51], s85 offen offset:1024 sc1
  s_barrier
  s_lshl_b32 s4, s6, 2
  s_add_u32 s4, s4, s5
  s_lshl_b32 s4, s4, 8
  s_add_u32 s11, s4, 131072
  s_add_u32 s12, s4, 262144
  s_lshl_b32 s86, s5, 14
  s_add_u32 s86, s86, 131072
  s_mov_b32 s88, 0
  s_mov_b32 s89, 0
  s_mov_b32 s64, s16
  s_mov_b32 s65, s17
  s_mov_b32 s66, 0x800
  s_mov_b32 s67, 0x20000
  s_mov_b32 s56, s22
  s_mov_b32 s57, s23
  s_mov_b32 s58, 0x800000
  s_mov_b32 s59, 0x20000
  s_lshl_b32 s4, s3, 6
  v_add_u32 v3, s4, v0
  v_lshlrev_b32 v166, 5, v0
  buffer_load_dwordx4 v[36:39], v166, s[64:67], 0 offen
  buffer_load_dwordx4 v[40:43], v166, s[64:67], 0 offen offset:16
  v_and_b32 v162, 15, v0
  v_lshrrev_b32 v163, 5, v0
  v_lshlrev_b32 v162, 2, v162
  v_lshl_add_u32 v162, v163, 1, v162
  v_bfe_u32 v163, v0, 4, 1
  v_add3_u32 v17, v162, v163, s4
  v_lshlrev_b32 v166, 1, v17
  s_lshl_b32 s14, s5, 9
  buffer_load_ushort v164, v166, s[64:67], s14 offen
  v_lshlrev_b32 v166, 16, v1
  v_add_u32 v166, v166, v2
  s_lshl_b32 s4, s5, 8
  s_lshl_b32 s14, s3, 6
  s_add_u32 s15, s4, s14
  s_lshl_b32 s4, s15, 13
  s_lshl_b32 s14, s6, 7
  s_add_u32 s4, s4, s14
  buffer_load_dwordx4 v[84:87], v166, s[56:59], s4 offen nt
  s_add_u32 s4, s4, 8192
  buffer_load_dwordx4 v[88:91], v166, s[56:59], s4 offen nt
  s_add_u32 s4, s4, 8192
  buffer_load_dwordx4 v[92:95], v166, s[56:59], s4 offen nt
  s_add_u32 s4, s4, 8192
  buffer_load_dwordx4 v[96:99], v166, s[56:59], s4 offen nt
  s_add_u32 s4, s4, 8192
  buffer_load_dwordx4 v[100:103], v166, s[56:59], s4 offen nt
  s_add_u32 s4, s4, 8192
  buffer_load_dwordx4 v[104:107], v166, s[56:59], s4 offen nt
  s_add_u32 s4, s4, 8192
  buffer_load_dwordx4 v[108:111], v166, s[56:59], s4 offen nt
  s_add_u32 s4, s4, 8192
  buffer_load_dwordx4 v[112:115], v166, s[56:59], s4 offen nt
  v_lshrrev_b32 v10, 4, v3
  v_lshlrev_b32 v10, 10, v10
  v_and_b32 v11, 15, v3
  v_lshl_add_u32 v19, v11, 4, v10
  buffer_load_dword v7, v4, s[48:51], s11 offen sc1
  buffer_load_dwordx4 v[68:71], v19, s[48:51], s86 offen offset:0 sc1
  buffer_load_dwordx4 v[72:75], v19, s[48:51], s86 offen offset:256 sc1
  buffer_load_dwordx4 v[76:79], v19, s[48:51], s86 offen offset:512 sc1
  buffer_load_dwordx4 v[80:83], v19, s[48:51], s86 offen offset:768 sc1
  v_and_b32 v16, 60, v4
  v_lshlrev_b32 v18, 3, v3
  v_lshlrev_b32 v8, 1, v2
  v_bfe_u32 v9, v0, 5, 1
  v_lshl_add_u32 v8, v9, 4, v8
  v_bfe_u32 v9, v0, 4, 1
  v_lshl_add_u32 v8, v9, 3, v8
  s_lshl_b32 s4, s3, 8
  v_add_u32 v167, s4, v8
  s_lshl_b32 s4, s2, 6
  s_add_u32 s13, s4, 327680
  s_mov_b32 s101, 0x3fb8aa3b
  s_mov_b32 s100, 0x1f8
  s_mov_b32 s68, s42
  s_mov_b32 s69, s43
  s_mov_b32 s70, 0x100
  s_mov_b32 s71, 0x20000
  s_mov_b32 s72, s24
  s_mov_b32 s73, s25
  s_mov_b32 s74, 0x800000
  s_mov_b32 s75, 0x20000
  s_waitcnt vmcnt(21)
  v_lshlrev_b32 v148, 16, v160
  v_and_b32 v149, 0xffff0000, v160
  v_lshlrev_b32 v150, 16, v161
  v_and_b32 v151, 0xffff0000, v161
  v_mul_f32 v8, 0xbfb8aa3b, v148
  v_mul_f32 v9, 0xbfb8aa3b, v149
  v_fma_f32 v10, -v148, s101, -v8
  v_fma_f32 v11, -v149, s101, -v9
  v_fmac_f32 v10, 0xb2a57060, v148
  v_fmac_f32 v11, 0xb2a57060, v149
  v_min_f32 v8, 0x42fc0000, v8
  v_min_f32 v9, 0x42fc0000, v9
  v_exp_f32 v8, v8
  v_exp_f32 v9, v9
  v_mul_f32 v10, 0x3f317218, v10
  v_mul_f32 v11, 0x3f317218, v11
  v_fmac_f32 v8, v8, v10
  v_fmac_f32 v9, v9, v11
  v_add_f32 v8, 1.0, v8
  v_add_f32 v9, 1.0, v9
  v_rcp_f32 v10, v8
  v_rcp_f32 v11, v9
  v_mul_f32 v12, v148, v10
  v_mul_f32 v13, v149, v11
  v_fma_f32 v8, -v12, v8, v148
  v_fma_f32 v9, -v13, v9, v149
  v_fma_f32 v8, v8, v10, v12
  v_fma_f32 v9, v9, v11, v13
  v_cmp_class_f32 vcc, v8, s100
  s_nop 1
  v_cndmask_b32 v148, v12, v8, vcc
  v_cmp_class_f32 vcc, v9, s100
  s_nop 1
  v_cndmask_b32 v149, v13, v9, vcc
  v_cvt_pk_bf16_f32 v8, v148, v149
  v_lshlrev_b32 v148, 16, v8
  v_and_b32 v149, 0xffff0000, v8
  v_mul_f32 v8, 0xbfb8aa3b, v150
  v_mul_f32 v9, 0xbfb8aa3b, v151
  v_fma_f32 v10, -v150, s101, -v8
  v_fma_f32 v11, -v151, s101, -v9
  v_fmac_f32 v10, 0xb2a57060, v150
  v_fmac_f32 v11, 0xb2a57060, v151
  v_min_f32 v8, 0x42fc0000, v8
  v_min_f32 v9, 0x42fc0000, v9
  v_exp_f32 v8, v8
  v_exp_f32 v9, v9
  v_mul_f32 v10, 0x3f317218, v10
  v_mul_f32 v11, 0x3f317218, v11
  v_fmac_f32 v8, v8, v10
  v_fmac_f32 v9, v9, v11
  v_add_f32 v8, 1.0, v8
  v_add_f32 v9, 1.0, v9
  v_rcp_f32 v10, v8
  v_rcp_f32 v11, v9
  v_mul_f32 v12, v150, v10
  v_mul_f32 v13, v151, v11
  v_fma_f32 v8, -v12, v8, v150
  v_fma_f32 v9, -v13, v9, v151
  v_fma_f32 v8, v8, v10, v12
  v_fma_f32 v9, v9, v11, v13
  v_cmp_class_f32 vcc, v8, s100
  s_nop 1
  v_cndmask_b32 v150, v12, v8, vcc
  v_cmp_class_f32 vcc, v9, s100
  s_nop 1
  v_cndmask_b32 v151, v13, v9, vcc
  v_cvt_pk_bf16_f32 v8, v150, v151
  v_lshlrev_b32 v150, 16, v8
  v_and_b32 v151, 0xffff0000, v8
  v_lshlrev_b32 v8, 16, v20
  v_and_b32 v9, 0xffff0000, v20
  v_pk_mul_f32 v[44:45], v[8:9], v[148:149] op_sel_hi:[1,0]
  v_lshlrev_b32 v10, 16, v21
  v_and_b32 v11, 0xffff0000, v21
  v_pk_mul_f32 v[46:47], v[10:11], v[148:149] op_sel_hi:[1,0]
  v_lshlrev_b32 v8, 16, v22
  v_and_b32 v9, 0xffff0000, v22
  v_pk_mul_f32 v[48:49], v[8:9], v[148:149] op_sel_hi:[1,0]
  v_lshlrev_b32 v10, 16, v23
  v_and_b32 v11, 0xffff0000, v23
  v_pk_mul_f32 v[50:51], v[10:11], v[148:149] op_sel_hi:[1,0]
  v_lshlrev_b32 v8, 16, v24
  v_and_b32 v9, 0xffff0000, v24
  v_pk_fma_f32 v[44:45], v[8:9], v[148:149], v[44:45] op_sel:[0,1,0] op_sel_hi:[1,1,1]
  v_lshlrev_b32 v10, 16, v25
  v_and_b32 v11, 0xffff0000, v25
  v_pk_fma_f32 v[46:47], v[10:11], v[148:149], v[46:47] op_sel:[0,1,0] op_sel_hi:[1,1,1]
  v_lshlrev_b32 v8, 16, v26
  v_and_b32 v9, 0xffff0000, v26
  v_pk_fma_f32 v[48:49], v[8:9], v[148:149], v[48:49] op_sel:[0,1,0] op_sel_hi:[1,1,1]
  v_lshlrev_b32 v10, 16, v27
  v_and_b32 v11, 0xffff0000, v27
  v_pk_fma_f32 v[50:51], v[10:11], v[148:149], v[50:51] op_sel:[0,1,0] op_sel_hi:[1,1,1]
  v_lshlrev_b32 v8, 16, v28
  v_and_b32 v9, 0xffff0000, v28
  v_pk_fma_f32 v[44:45], v[8:9], v[150:151], v[44:45] op_sel_hi:[1,0,1]
  v_lshlrev_b32 v10, 16, v29
  v_and_b32 v11, 0xffff0000, v29
  v_pk_fma_f32 v[46:47], v[10:11], v[150:151], v[46:47] op_sel_hi:[1,0,1]
  v_lshlrev_b32 v8, 16, v30
  v_and_b32 v9, 0xffff0000, v30
  v_pk_fma_f32 v[48:49], v[8:9], v[150:151], v[48:49] op_sel_hi:[1,0,1]
  v_lshlrev_b32 v10, 16, v31
  v_and_b32 v11, 0xffff0000, v31
  v_pk_fma_f32 v[50:51], v[10:11], v[150:151], v[50:51] op_sel_hi:[1,0,1]
  v_lshlrev_b32 v8, 16, v32
  v_and_b32 v9, 0xffff0000, v32
  v_pk_fma_f32 v[44:45], v[8:9], v[150:151], v[44:45] op_sel:[0,1,0] op_sel_hi:[1,1,1]
  v_lshlrev_b32 v10, 16, v33
  v_and_b32 v11, 0xffff0000, v33
  v_pk_fma_f32 v[46:47], v[10:11], v[150:151], v[46:47] op_sel:[0,1,0] op_sel_hi:[1,1,1]
  v_lshlrev_b32 v8, 16, v34
  v_and_b32 v9, 0xffff0000, v34
  v_pk_fma_f32 v[48:49], v[8:9], v[150:151], v[48:49] op_sel:[0,1,0] op_sel_hi:[1,1,1]
  v_lshlrev_b32 v10, 16, v35
  v_and_b32 v11, 0xffff0000, v35
  v_pk_fma_f32 v[50:51], v[10:11], v[150:151], v[50:51] op_sel:[0,1,0] op_sel_hi:[1,1,1]
  v_permlane32_swap_b32 v44, v48
  v_permlane32_swap_b32 v45, v49
  v_permlane32_swap_b32 v46, v50
  v_permlane32_swap_b32 v47, v51
  v_add_f32 v44, v44, v48
  v_add_f32 v45, v45, v49
  v_add_f32 v46, v46, v50
  v_add_f32 v47, v47, v51
  s_nop 0
  v_permlane16_swap_b32 v44, v46
  v_permlane16_swap_b32 v45, v47
  v_add_f32 v44, v44, v46
  v_add_f32 v45, v45, v47
  s_nop 0
  v_add_f32_dpp v44, v44, v44 row_ror:8 row_mask:0xf bank_mask:0xf
  v_add_f32_dpp v45, v45, v45 row_ror:8 row_mask:0xf bank_mask:0xf
  ds_write_b64 v167, v[44:45] offset:3328
  v_mov_b32 v10, 0
  v_mov_b32 v11, 1
  s_mov_b64 exec, 1
  ds_add_rtn_u32 v11, v10, v11 offset:0
  s_waitcnt lgkmcnt(0)
  s_mov_b64 exec, -1
  v_readfirstlane_b32 s4, v11
  s_nop 0
  s_cmp_lg_u32 s4, 3
  s_cbranch_scc1 L_pubM_1
  ds_read_b32 v44, v4 offset:3328
  ds_read_b32 v45, v4 offset:3584
  ds_read_b32 v46, v4 offset:3840
  ds_read_b32 v47, v4 offset:4096
  s_waitcnt lgkmcnt(0)
  v_add_f32 v44, v44, v45
  v_add_f32 v46, v46, v47
  v_add_f32 v44, v44, v46
  s_waitcnt vmcnt(20)
  v_add_u32 v45, 1, v6
  v_bfi_b32 v6, 3, v45, v44
  buffer_store_dword v6, v4, s[48:51], s10 offen sc1
  s_mov_b32 s88, 1
L_pubM_1:
  s_waitcnt vmcnt(13)
  v_lshlrev_b32 v8, 16, v36
  v_and_b32 v9, 0xffff0000, v36
  v_add_f32 v162, v8, v9
  v_mul_f32 v163, v8, v8
  v_fmac_f32 v163, v9, v9
  v_lshlrev_b32 v8, 16, v37
  v_and_b32 v9, 0xffff0000, v37
  v_add_f32 v162, v162, v8
  v_fmac_f32 v163, v8, v8
  v_add_f32 v162, v162, v9
  v_fmac_f32 v163, v9, v9
  v_lshlrev_b32 v8, 16, v38
  v_and_b32 v9, 0xffff0000, v38
  v_add_f32 v162, v162, v8
  v_fmac_f32 v163, v8, v8
  v_add_f32 v162, v162, v9
  v_fmac_f32 v163, v9, v9
  v_lshlrev_b32 v8, 16, v39
  v_and_b32 v9, 0xffff0000, v39
  v_add_f32 v162, v162, v8
  v_fmac_f32 v163, v8, v8
  v_add_f32 v162, v162, v9
  v_fmac_f32 v163, v9, v9
  v_lshlrev_b32 v8, 16, v40
  v_and_b32 v9, 0xffff0000, v40
  v_add_f32 v162, v162, v8
  v_fmac_f32 v163, v8, v8
  v_add_f32 v162, v162, v9
  v_fmac_f32 v163, v9, v9
  v_lshlrev_b32 v8, 16, v41
  v_and_b32 v9, 0xffff0000, v41
  v_add_f32 v162, v162, v8
  v_fmac_f32 v163, v8, v8
  v_add_f32 v162, v162, v9
  v_fmac_f32 v163, v9, v9
  v_lshlrev_b32 v8, 16, v42
  v_and_b32 v9, 0xffff0000, v42
  v_add_f32 v162, v162, v8
  v_fmac_f32 v163, v8, v8
  v_add_f32 v162, v162, v9
  v_fmac_f32 v163, v9, v9
  v_lshlrev_b32 v8, 16, v43
  v_and_b32 v9, 0xffff0000, v43
  v_add_f32 v162, v162, v8
  v_fmac_f32 v163, v8, v8
  v_add_f32 v162, v162, v9
  v_fmac_f32 v163, v9, v9
  v_mov_b32 v8, v162
  v_mov_b32 v9, v163
  s_nop 0
  v_permlane32_swap_b32 v162, v8
  v_permlane32_swap_b32 v163, v9
  v_add_f32 v162, v162, v8
  v_add_f32 v163, v163, v9
  v_mov_b32 v8, v162
  v_mov_b32 v9, v163
  s_nop 0
  v_permlane16_swap_b32 v162, v8
  v_permlane16_swap_b32 v163, v9
  v_add_f32 v162, v162, v8
  v_add_f32 v163, v163, v9
  s_nop 0
  v_add_f32_dpp v162, v162, v162 row_ror:8 row_mask:0xf bank_mask:0xf
  v_add_f32_dpp v163, v163, v163 row_ror:8 row_mask:0xf bank_mask:0xf
  s_nop 0
  v_add_f32_dpp v162, v162, v162 row_ror:4 row_mask:0xf bank_mask:0xf
  v_add_f32_dpp v163, v163, v163 row_ror:4 row_mask:0xf bank_mask:0xf
  s_nop 0
  v_add_f32_dpp v162, v162, v162 row_ror:2 row_mask:0xf bank_mask:0xf
  v_add_f32_dpp v163, v163, v163 row_ror:2 row_mask:0xf bank_mask:0xf
  s_nop 0
  v_add_f32_dpp v162, v162, v162 row_ror:1 row_mask:0xf bank_mask:0xf
  v_add_f32_dpp v163, v163, v163 row_ror:1 row_mask:0xf bank_mask:0xf
  v_mul_f32 v162, 0x3a800000, v162
  v_mul_f32 v163, 0x3a800000, v163
  v_fma_f32 v163, -v162, v162, v163
  v_max_f32 v163, 0, v163
  v_cvt_pk_bf16_f32 v8, v162, v163
  v_lshlrev_b32 v162, 16, v8
  v_and_b32 v163, 0xffff0000, v8
  v_add_f32 v163, 0x3727c5ac, v163
  v_cvt_pk_bf16_f32 v163, v163, v163
  v_and_b32 v163, 0xffff0000, v163
  v_sqrt_f32 v163, v163
  s_nop 0
  v_cvt_pk_bf16_f32 v163, v163, v163
  v_and_b32 v163, 0xffff0000, v163
  v_rcp_f32 v163, v163
  v_lshlrev_b32 v164, 16, v164
  v_sub_f32 v164, v164, v162
  v_cvt_pk_bf16_f32 v164, v164, v164
  v_and_b32 v164, 0xffff0000, v164
  v_mul_f32 v164, v164, v163
  v_cvt_pk_bf16_f32 v164, v164, v164
  v_and_b32 v164, 0xffff0000, v164
  s_mov_b32 s14, 65536
  buffer_load_dwordx4 v[116:119], v5, s[48:51], s84 offen offset:0 sc1
  buffer_load_dwordx4 v[120:123], v5, s[48:51], s84 offen offset:1024 sc1
  buffer_load_dwordx4 v[124:127], v5, s[48:51], s85 offen offset:0 sc1
  buffer_load_dwordx4 v[128:131], v5, s[48:51], s85 offen offset:1024 sc1
  s_waitcnt vmcnt(0)
  v_mov_b32 v10, 0
  v_mov_b32 v11, 1
  s_mov_b64 exec, 1
  ds_add_u32 v10, v11 offset:24
  s_mov_b64 exec, -1
  s_branch L_tgmMP_4
L_tgMP_2:
  buffer_load_dwordx4 v[116:119], v5, s[48:51], s84 offen offset:0 sc1
  buffer_load_dwordx4 v[120:123], v5, s[48:51], s84 offen offset:1024 sc1
  buffer_load_dwordx4 v[124:127], v5, s[48:51], s85 offen offset:0 sc1
  buffer_load_dwordx4 v[128:131], v5, s[48:51], s85 offen offset:1024 sc1
  s_waitcnt vmcnt(0)
L_tgmMP_4:
  v_xor_b32 v8, v116, v52
  v_and_b32 v8, 3, v8
  v_xor_b32 v10, v117, v53
  v_and_b32 v10, 3, v10
  v_min_u32 v8, v8, v10
  v_xor_b32 v10, v118, v54
  v_and_b32 v10, 3, v10
  v_min_u32 v8, v8, v10
  v_xor_b32 v10, v119, v55
  v_and_b32 v10, 3, v10
  v_min_u32 v8, v8, v10
  v_xor_b32 v10, v120, v56
  v_and_b32 v10, 3, v10
  v_min_u32 v8, v8, v10
  v_xor_b32 v10, v121, v57
  v_and_b32 v10, 3, v10
  v_min_u32 v8, v8, v10
  v_xor_b32 v10, v122, v58
  v_and_b32 v10, 3, v10
  v_min_u32 v8, v8, v10
  v_xor_b32 v10, v123, v59
  v_and_b32 v10, 3, v10
  v_min_u32 v8, v8, v10
  v_xor_b32 v9, v124, v60
  v_and_b32 v9, 3, v9
  v_xor_b32 v11, v125, v61
  v_and_b32 v11, 3, v11
  v_min_u32 v9, v9, v11
  v_xor_b32 v11, v126, v62
  v_and_b32 v11, 3, v11
  v_min_u32 v9, v9, v11
  v_xor_b32 v11, v127, v63
  v_and_b32 v11, 3, v11
  v_min_u32 v9, v9, v11
  v_xor_b32 v11, v128, v64
  v_and_b32 v11, 3, v11
  v_min_u32 v9, v9, v11
  v_xor_b32 v11, v129, v65
  v_and_b32 v11, 3, v11
  v_min_u32 v9, v9, v11
  v_xor_b32 v11, v130, v66
  v_and_b32 v11, 3, v11
  v_min_u32 v9, v9, v11
  v_xor_b32 v11, v131, v67
  v_and_b32 v11, 3, v11
  v_min_u32 v9, v9, v11
  v_min_u32 v8, v8, v9
  v_cmp_eq_u32 vcc, 0, v8
  s_cbranch_vccz L_tgxMP_3
  s_mov_b64 exec, vcc
  s_sleep 8
  s_sub_u32 s14, s14, 1
  s_cmp_eq_u32 s14, 0
  s_cbranch_scc1 L_tgxMP_3
  s_and_b32 s4, s14, 3
  s_cbranch_scc1 L_tgMP_2
  s_mov_b64 s[90:91], exec
  s_mov_b64 exec, 1
  v_mov_b32 v11, 0
  buffer_load_dword v10, v11, s[68:71], 0 offen offset:128 sc1
  s_waitcnt vmcnt(0)
  v_readfirstlane_b32 s4, v10
  s_mov_b64 exec, s[90:91]
  s_cmp_eq_u32 s4, 0
  s_cbranch_scc1 L_tgMP_2
  s_mov_b64 exec, -1
  s_cmp_eq_u32 s88, 0
  s_cbranch_scc1 L_sw2MPM_5
  s_mov_b32 s88, 0
  v_add_u32 v10, 1, v6
  v_bfi_b32 v10, 3, v10, v6
  buffer_store_dword v10, v4, s[48:51], s10 offen sc1
L_sw2MPM_5:
  s_cmp_eq_u32 s89, 0
  s_cbranch_scc1 L_sw2MPQ_6
  s_mov_b32 s89, 0
  v_add_u32 v10, 1, v7
  v_bfi_b32 v10, 3, v10, v7
  buffer_store_dword v10, v4, s[48:51], s11 offen sc1
L_sw2MPQ_6:
  s_mov_b64 exec, s[90:91]
  s_branch L_tgMP_2
L_tgxMP_3:
  s_mov_b64 exec, -1
  v_and_b32 v116, -4, v116
  v_and_b32 v117, -4, v117
  v_and_b32 v118, -4, v118
  v_and_b32 v119, -4, v119
  v_and_b32 v120, -4, v120
  v_and_b32 v121, -4, v121
  v_and_b32 v122, -4, v122
  v_and_b32 v123, -4, v123
  v_and_b32 v124, -4, v124
  v_and_b32 v125, -4, v125
  v_and_b32 v126, -4, v126
  v_and_b32 v127, -4, v127
  v_and_b32 v128, -4, v128
  v_and_b32 v129, -4, v129
  v_and_b32 v130, -4, v130
  v_and_b32 v131, -4, v131
  v_pk_add_f32 v[116:117], v[116:117], v[120:121]
  v_pk_add_f32 v[118:119], v[118:119], v[122:123]
  v_pk_add_f32 v[124:125], v[124:125], v[128:129]
  v_pk_add_f32 v[126:127], v[126:127], v[130:131]
  v_permlane32_swap_b32 v116, v118
  v_permlane32_swap_b32 v117, v119
  v_permlane32_swap_b32 v124, v126
  v_permlane32_swap_b32 v125, v127
  v_pk_add_f32 v[116:117], v[116:117], v[118:119]
  v_pk_add_f32 v[124:125], v[124:125], v[126:127]
  s_nop 0
  v_permlane16_swap_b32 v116, v117
  v_permlane16_swap_b32 v124, v125
  v_add_f32 v116, v116, v117
  v_add_f32 v124, v124, v125
  v_cvt_pk_bf16_f32 v8, v116, v124
  v_lshlrev_b32 v116, 16, v8
  v_and_b32 v124, 0xffff0000, v8
  v_add_f32 v124, 1.0, v124
  v_cvt_pk_bf16_f32 v124, v124, v124
  v_and_b32 v124, 0xffff0000, v124
  v_mul_f32 v124, v124, v164
  v_cvt_pk_bf16_f32 v124, v124, v124
  v_and_b32 v124, 0xffff0000, v124
  v_add_f32 v124, v124, v116
  v_cvt_pk_bf16_f32 v124, v124, v124
  v_and_b32 v124, 0xffff0000, v124
  v_lshlrev_b32 v8, 2, v17
  ds_write_b32 v8, v124 offset:2304
  s_lshl_b32 s4, s3, 8
  v_lshlrev_b32 v8, 5, v1
  v_add_u32 v8, s4, v8
  s_waitcnt lgkmcnt(0)
  ds_read_b128 v[148:151], v8 offset:2304
  ds_read_b128 v[152:155], v8 offset:2320
  s_waitcnt lgkmcnt(0)
  v_lshlrev_b32 v8, 16, v84
  v_and_b32 v9, 0xffff0000, v84
  v_pk_mul_f32 v[44:45], v[8:9], v[148:149] op_sel_hi:[1,0]
  v_lshlrev_b32 v10, 16, v85
  v_and_b32 v11, 0xffff0000, v85
  v_pk_mul_f32 v[46:47], v[10:11], v[148:149] op_sel_hi:[1,0]
  v_lshlrev_b32 v8, 16, v86
  v_and_b32 v9, 0xffff0000, v86
  v_pk_mul_f32 v[48:49], v[8:9], v[148:149] op_sel_hi:[1,0]
  v_lshlrev_b32 v10, 16, v87
  v_and_b32 v11, 0xffff0000, v87
  v_pk_mul_f32 v[50:51], v[10:11], v[148:149] op_sel_hi:[1,0]
  v_lshlrev_b32 v8, 16, v88
  v_and_b32 v9, 0xffff0000, v88
  v_pk_fma_f32 v[44:45], v[8:9], v[148:149], v[44:45] op_sel:[0,1,0] op_sel_hi:[1,1,1]
  v_lshlrev_b32 v10, 16, v89
  v_and_b32 v11, 0xffff0000, v89
  v_pk_fma_f32 v[46:47], v[10:11], v[148:149], v[46:47] op_sel:[0,1,0] op_sel_hi:[1,1,1]
  v_lshlrev_b32 v8, 16, v90
  v_and_b32 v9, 0xffff0000, v90
  v_pk_fma_f32 v[48:49], v[8:9], v[148:149], v[48:49] op_sel:[0,1,0] op_sel_hi:[1,1,1]
  v_lshlrev_b32 v10, 16, v91
  v_and_b32 v11, 0xffff0000, v91
  v_pk_fma_f32 v[50:51], v[10:11], v[148:149], v[50:51] op_sel:[0,1,0] op_sel_hi:[1,1,1]
  v_lshlrev_b32 v8, 16, v92
  v_and_b32 v9, 0xffff0000, v92
  v_pk_fma_f32 v[44:45], v[8:9], v[150:151], v[44:45] op_sel_hi:[1,0,1]
  v_lshlrev_b32 v10, 16, v93
  v_and_b32 v11, 0xffff0000, v93
  v_pk_fma_f32 v[46:47], v[10:11], v[150:151], v[46:47] op_sel_hi:[1,0,1]
  v_lshlrev_b32 v8, 16, v94
  v_and_b32 v9, 0xffff0000, v94
  v_pk_fma_f32 v[48:49], v[8:9], v[150:151], v[48:49] op_sel_hi:[1,0,1]
  v_lshlrev_b32 v10, 16, v95
  v_and_b32 v11, 0xffff0000, v95
  v_pk_fma_f32 v[50:51], v[10:11], v[150:151], v[50:51] op_sel_hi:[1,0,1]
  v_lshlrev_b32 v8, 16, v96
  v_and_b32 v9, 0xffff0000, v96
  v_pk_fma_f32 v[44:45], v[8:9], v[150:151], v[44:45] op_sel:[0,1,0] op_sel_hi:[1,1,1]
  v_lshlrev_b32 v10, 16, v97
  v_and_b32 v11, 0xffff0000, v97
  v_pk_fma_f32 v[46:47], v[10:11], v[150:151], v[46:47] op_sel:[0,1,0] op_sel_hi:[1,1,1]
  v_lshlrev_b32 v8, 16, v98
  v_and_b32 v9, 0xffff0000, v98
  v_pk_fma_f32 v[48:49], v[8:9], v[150:151], v[48:49] op_sel:[0,1,0] op_sel_hi:[1,1,1]
  v_lshlrev_b32 v10, 16, v99
  v_and_b32 v11, 0xffff0000, v99
  v_pk_fma_f32 v[50:51], v[10:11], v[150:151], v[50:51] op_sel:[0,1,0] op_sel_hi:[1,1,1]
  v_lshlrev_b32 v8, 16, v100
  v_and_b32 v9, 0xffff0000, v100
  v_pk_fma_f32 v[44:45], v[8:9], v[152:153], v[44:45] op_sel_hi:[1,0,1]
  v_lshlrev_b32 v10, 16, v101
  v_and_b32 v11, 0xffff0000, v101
  v_pk_fma_f32 v[46:47], v[10:11], v[152:153], v[46:47] op_sel_hi:[1,0,1]
  v_lshlrev_b32 v8, 16, v102
  v_and_b32 v9, 0xffff0000, v102
  v_pk_fma_f32 v[48:49], v[8:9], v[152:153], v[48:49] op_sel_hi:[1,0,1]
  v_lshlrev_b32 v10, 16, v103
  v_and_b32 v11, 0xffff0000, v103
  v_pk_fma_f32 v[50:51], v[10:11], v[152:153], v[50:51] op_sel_hi:[1,0,1]
  v_lshlrev_b32 v8, 16, v104
  v_and_b32 v9, 0xffff0000, v104
  v_pk_fma_f32 v[44:45], v[8:9], v[152:153], v[44:45] op_sel:[0,1,0] op_sel_hi:[1,1,1]
  v_lshlrev_b32 v10, 16, v105
  v_and_b32 v11, 0xffff0000, v105
  v_pk_fma_f32 v[46:47], v[10:11], v[152:153], v[46:47] op_sel:[0,1,0] op_sel_hi:[1,1,1]
  v_lshlrev_b32 v8, 16, v106
  v_and_b32 v9, 0xffff0000, v106
  v_pk_fma_f32 v[48:49], v[8:9], v[152:153], v[48:49] op_sel:[0,1,0] op_sel_hi:[1,1,1]
  v_lshlrev_b32 v10, 16, v107
  v_and_b32 v11, 0xffff0000, v107
  v_pk_fma_f32 v[50:51], v[10:11], v[152:153], v[50:51] op_sel:[0,1,0] op_sel_hi:[1,1,1]
  v_lshlrev_b32 v8, 16, v108
  v_and_b32 v9, 0xffff0000, v108
  v_pk_fma_f32 v[44:45], v[8:9], v[154:155], v[44:45] op_sel_hi:[1,0,1]
  v_lshlrev_b32 v10, 16, v109
  v_and_b32 v11, 0xffff0000, v109
  v_pk_fma_f32 v[46:47], v[10:11], v[154:155], v[46:47] op_sel_hi:[1,0,1]
  v_lshlrev_b32 v8, 16, v110
  v_and_b32 v9, 0xffff0000, v110
  v_pk_fma_f32 v[48:49], v[8:9], v[154:155], v[48:49] op_sel_hi:[1,0,1]
  v_lshlrev_b32 v10, 16, v111
  v_and_b32 v11, 0xffff0000, v111
  v_pk_fma_f32 v[50:51], v[10:11], v[154:155], v[50:51] op_sel_hi:[1,0,1]
  v_lshlrev_b32 v8, 16, v112
  v_and_b32 v9, 0xffff0000, v112
  v_pk_fma_f32 v[44:45], v[8:9], v[154:155], v[44:45] op_sel:[0,1,0] op_sel_hi:[1,1,1]
  v_lshlrev_b32 v10, 16, v113
  v_and_b32 v11, 0xffff0000, v113
  v_pk_fma_f32 v[46:47], v[10:11], v[154:155], v[46:47] op_sel:[0,1,0] op_sel_hi:[1,1,1]
  v_lshlrev_b32 v8, 16, v114
  v_and_b32 v9, 0xffff0000, v114
  v_pk_fma_f32 v[48:49], v[8:9], v[154:155], v[48:49] op_sel:[0,1,0] op_sel_hi:[1,1,1]
  v_lshlrev_b32 v10, 16, v115
  v_and_b32 v11, 0xffff0000, v115
  v_pk_fma_f32 v[50:51], v[10:11], v[154:155], v[50:51] op_sel:[0,1,0] op_sel_hi:[1,1,1]
  v_permlane32_swap_b32 v44, v48
  v_permlane32_swap_b32 v45, v49
  v_permlane32_swap_b32 v46, v50
  v_permlane32_swap_b32 v47, v51
  v_add_f32 v44, v44, v48
  v_add_f32 v45, v45, v49
  v_add_f32 v46, v46, v50
  v_add_f32 v47, v47, v51
  s_nop 0
  v_permlane16_swap_b32 v44, v46
  v_permlane16_swap_b32 v45, v47
  v_add_f32 v44, v44, v46
  v_add_f32 v45, v45, v47
  s_nop 0
  v_add_f32_dpp v44, v44, v44 row_ror:8 row_mask:0xf bank_mask:0xf
  v_add_f32_dpp v45, v45, v45 row_ror:8 row_mask:0xf bank_mask:0xf
  ds_write_b64 v167, v[44:45] offset:5376
  v_mov_b32 v10, 0
  v_mov_b32 v11, 1
  s_mov_b64 exec, 1
  ds_add_rtn_u32 v11, v10, v11 offset:8
  s_waitcnt lgkmcnt(0)
  s_mov_b64 exec, -1
  v_readfirstlane_b32 s4, v11
  s_nop 0
  s_cmp_lg_u32 s4, 3
  s_cbranch_scc1 L_pubQ_7
  ds_read_b32 v44, v4 offset:5376
  ds_read_b32 v45, v4 offset:5632
  ds_read_b32 v46, v4 offset:5888
  ds_read_b32 v47, v4 offset:6144
  s_waitcnt lgkmcnt(0)
  v_add_f32 v44, v44, v45
  v_add_f32 v46, v46, v47
  v_add_f32 v44, v44, v46
  v_add_u32 v45, 1, v7
  v_bfi_b32 v7, 3, v45, v44
  buffer_store_dword v7, v4, s[48:51], s11 offen sc1
  s_mov_b32 s89, 1
L_pubQ_7:
  v_mul_u32_u24 v165, 98304, v1
  v_add_u32 v165, v165, v2
  s_lshl_b32 s4, s5, 8
  s_lshl_b32 s14, s3, 6
  s_add_u32 s15, s4, s14
  s_lshl_b32 s14, s6, 7
  s_mul_i32 s4, s15, 12288
  s_add_u32 s4, s4, s14
  s_add_u32 s4, s4, 4096
  s_lshl_b32 s15, s15, 1
  v_lshlrev_b32 v166, 4, v1
  buffer_load_dwordx4 v[156:159], v166, s[60:63], s15 offen
  buffer_load_dwordx4 v[116:119], v165, s[52:55], s4 offen nt
  s_add_u32 s4, s4, 12288
  buffer_load_dwordx4 v[120:123], v165, s[52:55], s4 offen nt
  s_add_u32 s4, s4, 12288
  buffer_load_dwordx4 v[124:127], v165, s[52:55], s4 offen nt
  s_add_u32 s4, s4, 12288
  buffer_load_dwordx4 v[128:131], v165, s[52:55], s4 offen nt
  s_add_u32 s4, s4, 12288
  buffer_load_dwordx4 v[132:135], v165, s[52:55], s4 offen nt
  s_add_u32 s4, s4, 12288
  buffer_load_dwordx4 v[136:139], v165, s[52:55], s4 offen nt
  s_add_u32 s4, s4, 12288
  buffer_load_dwordx4 v[140:143], v165, s[52:55], s4 offen nt
  s_add_u32 s4, s4, 12288
  buffer_load_dwordx4 v[144:147], v165, s[52:55], s4 offen nt
  s_mov_b32 s76, s28
  s_mov_b32 s77, s29
  s_mov_b32 s78, 0x700000
  s_mov_b32 s79, 0x20000
  s_mov_b32 s14, 65536
  buffer_load_dwordx4 v[84:87], v19, s[48:51], s86 offen offset:0 sc1
  buffer_load_dwordx4 v[88:91], v19, s[48:51], s86 offen offset:256 sc1
  buffer_load_dwordx4 v[92:95], v19, s[48:51], s86 offen offset:512 sc1
  buffer_load_dwordx4 v[96:99], v19, s[48:51], s86 offen offset:768 sc1
  s_waitcnt vmcnt(0)
  s_branch L_tgmQP_10
L_tgQP_8:
  buffer_load_dwordx4 v[84:87], v19, s[48:51], s86 offen offset:0 sc1
  buffer_load_dwordx4 v[88:91], v19, s[48:51], s86 offen offset:256 sc1
  buffer_load_dwordx4 v[92:95], v19, s[48:51], s86 offen offset:512 sc1
  buffer_load_dwordx4 v[96:99], v19, s[48:51], s86 offen offset:768 sc1
  s_waitcnt vmcnt(0)
L_tgmQP_10:
  v_xor_b32 v8, v84, v68
  v_and_b32 v8, 3, v8
  v_xor_b32 v10, v85, v69
  v_and_b32 v10, 3, v10
  v_min_u32 v8, v8, v10
  v_xor_b32 v10, v86, v70
  v_and_b32 v10, 3, v10
  v_min_u32 v8, v8, v10
  v_xor_b32 v10, v87, v71
  v_and_b32 v10, 3, v10
  v_min_u32 v8, v8, v10
  v_xor_b32 v10, v88, v72
  v_and_b32 v10, 3, v10
  v_min_u32 v8, v8, v10
  v_xor_b32 v10, v89, v73
  v_and_b32 v10, 3, v10
  v_min_u32 v8, v8, v10
  v_xor_b32 v10, v90, v74
  v_and_b32 v10, 3, v10
  v_min_u32 v8, v8, v10
  v_xor_b32 v10, v91, v75
  v_and_b32 v10, 3, v10
  v_min_u32 v8, v8, v10
  v_xor_b32 v9, v92, v76
  v_and_b32 v9, 3, v9
  v_xor_b32 v11, v93, v77
  v_and_b32 v11, 3, v11
  v_min_u32 v9, v9, v11
  v_xor_b32 v11, v94, v78
  v_and_b32 v11, 3, v11
  v_min_u32 v9, v9, v11
  v_xor_b32 v11, v95, v79
  v_and_b32 v11, 3, v11
  v_min_u32 v9, v9, v11
  v_xor_b32 v11, v96, v80
  v_and_b32 v11, 3, v11
  v_min_u32 v9, v9, v11
  v_xor_b32 v11, v97, v81
  v_and_b32 v11, 3, v11
  v_min_u32 v9, v9, v11
  v_xor_b32 v11, v98, v82
  v_and_b32 v11, 3, v11
  v_min_u32 v9, v9, v11
  v_xor_b32 v11, v99, v83
  v_and_b32 v11, 3, v11
  v_min_u32 v9, v9, v11
  v_min_u32 v8, v8, v9
  v_cmp_eq_u32 vcc, 0, v8
  s_cbranch_vccz L_tgxQP_9
  s_mov_b64 exec, vcc
  s_sleep 8
  s_sub_u32 s14, s14, 1
  s_cmp_eq_u32 s14, 0
  s_cbranch_scc1 L_tgxQP_9
  s_and_b32 s4, s14, 3
  s_cbranch_scc1 L_tgQP_8
  s_mov_b64 s[90:91], exec
  s_mov_b64 exec, 1
  v_mov_b32 v11, 0
  buffer_load_dword v10, v11, s[68:71], 0 offen offset:128 sc1
  s_waitcnt vmcnt(0)
  v_readfirstlane_b32 s4, v10
  s_mov_b64 exec, s[90:91]
  s_cmp_eq_u32 s4, 0
  s_cbranch_scc1 L_tgQP_8
  s_mov_b64 exec, -1
  s_cmp_eq_u32 s88, 0
  s_cbranch_scc1 L_sw2QPM_11
  s_mov_b32 s88, 0
  v_add_u32 v10, 1, v6
  v_bfi_b32 v10, 3, v10, v6
  buffer_store_dword v10, v4, s[48:51], s10 offen sc1
L_sw2QPM_11:
  s_cmp_eq_u32 s89, 0
  s_cbranch_scc1 L_sw2QPQ_12
  s_mov_b32 s89, 0
  v_add_u32 v10, 1, v7
  v_bfi_b32 v10, 3, v10, v7
  buffer_store_dword v10, v4, s[48:51], s11 offen sc1
L_sw2QPQ_12:
  s_mov_b64 exec, s[90:91]
  s_branch L_tgQP_8
L_tgxQP_9:
  s_mov_b64 exec, -1
  v_and_b32 v84, -4, v84
  v_and_b32 v85, -4, v85
  v_and_b32 v86, -4, v86
  v_and_b32 v87, -4, v87
  v_and_b32 v88, -4, v88
  v_and_b32 v89, -4, v89
  v_and_b32 v90, -4, v90
  v_and_b32 v91, -4, v91
  v_and_b32 v92, -4, v92
  v_and_b32 v93, -4, v93
  v_and_b32 v94, -4, v94
  v_and_b32 v95, -4, v95
  v_and_b32 v96, -4, v96
  v_and_b32 v97, -4, v97
  v_and_b32 v98, -4, v98
  v_and_b32 v99, -4, v99
  v_pk_add_f32 v[84:85], v[84:85], v[88:89]
  v_pk_add_f32 v[92:93], v[92:93], v[96:97]
  v_pk_add_f32 v[86:87], v[86:87], v[90:91]
  v_pk_add_f32 v[94:95], v[94:95], v[98:99]
  v_pk_add_f32 v[84:85], v[84:85], v[92:93]
  v_pk_add_f32 v[86:87], v[86:87], v[94:95]
  v_cvt_pk_bf16_f32 v88, v84, v85
  v_cvt_pk_bf16_f32 v89, v86, v87
  ds_write_b64 v18, v[88:89] offset:256
  v_mov_b32 v10, 0
  v_mov_b32 v11, 1
  s_mov_b64 exec, 1
  ds_add_rtn_u32 v11, v10, v11 offset:12
  s_waitcnt lgkmcnt(0)
  s_mov_b64 exec, -1
  v_readfirstlane_b32 s4, v11
  v_mul_u32_u24 v19, 57344, v1
  v_add_u32 v19, v19, v2
  s_mov_b32 s37, s2
  s_waitcnt vmcnt(8)
  v_lshlrev_b32 v148, 16, v156
  v_and_b32 v149, 0xffff0000, v156
  v_lshlrev_b32 v150, 16, v157
  v_and_b32 v151, 0xffff0000, v157
  v_lshlrev_b32 v152, 16, v158
  v_and_b32 v153, 0xffff0000, v158
  v_lshlrev_b32 v154, 16, v159
  v_and_b32 v155, 0xffff0000, v159
  v_mul_f32 v8, 0xbfb8aa3b, v148
  v_mul_f32 v9, 0xbfb8aa3b, v149
  v_fma_f32 v10, -v148, s101, -v8
  v_fma_f32 v11, -v149, s101, -v9
  v_fmac_f32 v10, 0xb2a57060, v148
  v_fmac_f32 v11, 0xb2a57060, v149
  v_min_f32 v8, 0x42fc0000, v8
  v_min_f32 v9, 0x42fc0000, v9
  v_exp_f32 v8, v8
  v_exp_f32 v9, v9
  v_mul_f32 v10, 0x3f317218, v10
  v_mul_f32 v11, 0x3f317218, v11
  v_fmac_f32 v8, v8, v10
  v_fmac_f32 v9, v9, v11
  v_add_f32 v8, 1.0, v8
  v_add_f32 v9, 1.0, v9
  v_rcp_f32 v10, v8
  v_rcp_f32 v11, v9
  v_mul_f32 v12, v148, v10
  v_mul_f32 v13, v149, v11
  v_fma_f32 v8, -v12, v8, v148
  v_fma_f32 v9, -v13, v9, v149
  v_fma_f32 v8, v8, v10, v12
  v_fma_f32 v9, v9, v11, v13
  v_cmp_class_f32 vcc, v8, s100
  s_nop 1
  v_cndmask_b32 v148, v12, v8, vcc
  v_cmp_class_f32 vcc, v9, s100
  s_nop 1
  v_cndmask_b32 v149, v13, v9, vcc
  v_cvt_pk_bf16_f32 v8, v148, v149
  v_lshlrev_b32 v148, 16, v8
  v_and_b32 v149, 0xffff0000, v8
  v_mul_f32 v8, 0xbfb8aa3b, v150
  v_mul_f32 v9, 0xbfb8aa3b, v151
  v_fma_f32 v10, -v150, s101, -v8
  v_fma_f32 v11, -v151, s101, -v9
  v_fmac_f32 v10, 0xb2a57060, v150
  v_fmac_f32 v11, 0xb2a57060, v151
  v_min_f32 v8, 0x42fc0000, v8
  v_min_f32 v9, 0x42fc0000, v9
  v_exp_f32 v8, v8
  v_exp_f32 v9, v9
  v_mul_f32 v10, 0x3f317218, v10
  v_mul_f32 v11, 0x3f317218, v11
  v_fmac_f32 v8, v8, v10
  v_fmac_f32 v9, v9, v11
  v_add_f32 v8, 1.0, v8
  v_add_f32 v9, 1.0, v9
  v_rcp_f32 v10, v8
  v_rcp_f32 v11, v9
  v_mul_f32 v12, v150, v10
  v_mul_f32 v13, v151, v11
  v_fma_f32 v8, -v12, v8, v150
  v_fma_f32 v9, -v13, v9, v151
  v_fma_f32 v8, v8, v10, v12
  v_fma_f32 v9, v9, v11, v13
  v_cmp_class_f32 vcc, v8, s100
  s_nop 1
  v_cndmask_b32 v150, v12, v8, vcc
  v_cmp_class_f32 vcc, v9, s100
  s_nop 1
  v_cndmask_b32 v151, v13, v9, vcc
  v_cvt_pk_bf16_f32 v8, v150, v151
  v_lshlrev_b32 v150, 16, v8
  v_and_b32 v151, 0xffff0000, v8
  v_mul_f32 v8, 0xbfb8aa3b, v152
  v_mul_f32 v9, 0xbfb8aa3b, v153
  v_fma_f32 v10, -v152, s101, -v8
  v_fma_f32 v11, -v153, s101, -v9
  v_fmac_f32 v10, 0xb2a57060, v152
  v_fmac_f32 v11, 0xb2a57060, v153
  v_min_f32 v8, 0x42fc0000, v8
  v_min_f32 v9, 0x42fc0000, v9
  v_exp_f32 v8, v8
  v_exp_f32 v9, v9
  v_mul_f32 v10, 0x3f317218, v10
  v_mul_f32 v11, 0x3f317218, v11
  v_fmac_f32 v8, v8, v10
  v_fmac_f32 v9, v9, v11
  v_add_f32 v8, 1.0, v8
  v_add_f32 v9, 1.0, v9
  v_rcp_f32 v10, v8
  v_rcp_f32 v11, v9
  v_mul_f32 v12, v152, v10
  v_mul_f32 v13, v153, v11
  v_fma_f32 v8, -v12, v8, v152
  v_fma_f32 v9, -v13, v9, v153
  v_fma_f32 v8, v8, v10, v12
  v_fma_f32 v9, v9, v11, v13
  v_cmp_class_f32 vcc, v8, s100
  s_nop 1
  v_cndmask_b32 v152, v12, v8, vcc
  v_cmp_class_f32 vcc, v9, s100
  s_nop 1
  v_cndmask_b32 v153, v13, v9, vcc
  v_cvt_pk_bf16_f32 v8, v152, v153
  v_lshlrev_b32 v152, 16, v8
  v_and_b32 v153, 0xffff0000, v8
  v_mul_f32 v8, 0xbfb8aa3b, v154
  v_mul_f32 v9, 0xbfb8aa3b, v155
  v_fma_f32 v10, -v154, s101, -v8
  v_fma_f32 v11, -v155, s101, -v9
  v_fmac_f32 v10, 0xb2a57060, v154
  v_fmac_f32 v11, 0xb2a57060, v155
  v_min_f32 v8, 0x42fc0000, v8
  v_min_f32 v9, 0x42fc0000, v9
  v_exp_f32 v8, v8
  v_exp_f32 v9, v9
  v_mul_f32 v10, 0x3f317218, v10
  v_mul_f32 v11, 0x3f317218, v11
  v_fmac_f32 v8, v8, v10
  v_fmac_f32 v9, v9, v11
  v_add_f32 v8, 1.0, v8
  v_add_f32 v9, 1.0, v9
  v_rcp_f32 v10, v8
  v_rcp_f32 v11, v9
  v_mul_f32 v12, v154, v10
  v_mul_f32 v13, v155, v11
  v_fma_f32 v8, -v12, v8, v154
  v_fma_f32 v9, -v13, v9, v155
  v_fma_f32 v8, v8, v10, v12
  v_fma_f32 v9, v9, v11, v13
  v_cmp_class_f32 vcc, v8, s100
  s_nop 1
  v_cndmask_b32 v154, v12, v8, vcc
  v_cmp_class_f32 vcc, v9, s100
  s_nop 1
  v_cndmask_b32 v155, v13, v9, vcc
  v_cvt_pk_bf16_f32 v8, v154, v155
  v_lshlrev_b32 v154, 16, v8
  v_and_b32 v155, 0xffff0000, v8
  s_waitcnt vmcnt(0)
  v_lshlrev_b32 v8, 16, v116
  v_and_b32 v9, 0xffff0000, v116
  v_pk_mul_f32 v[44:45], v[8:9], v[148:149] op_sel_hi:[1,0]
  v_lshlrev_b32 v10, 16, v117
  v_and_b32 v11, 0xffff0000, v117
  v_pk_mul_f32 v[46:47], v[10:11], v[148:149] op_sel_hi:[1,0]
  v_lshlrev_b32 v8, 16, v118
  v_and_b32 v9, 0xffff0000, v118
  v_pk_mul_f32 v[48:49], v[8:9], v[148:149] op_sel_hi:[1,0]
  v_lshlrev_b32 v10, 16, v119
  v_and_b32 v11, 0xffff0000, v119
  v_pk_mul_f32 v[50:51], v[10:11], v[148:149] op_sel_hi:[1,0]
  v_lshlrev_b32 v8, 16, v120
  v_and_b32 v9, 0xffff0000, v120
  v_pk_fma_f32 v[44:45], v[8:9], v[148:149], v[44:45] op_sel:[0,1,0] op_sel_hi:[1,1,1]
  v_lshlrev_b32 v10, 16, v121
  v_and_b32 v11, 0xffff0000, v121
  v_pk_fma_f32 v[46:47], v[10:11], v[148:149], v[46:47] op_sel:[0,1,0] op_sel_hi:[1,1,1]
  v_lshlrev_b32 v8, 16, v122
  v_and_b32 v9, 0xffff0000, v122
  v_pk_fma_f32 v[48:49], v[8:9], v[148:149], v[48:49] op_sel:[0,1,0] op_sel_hi:[1,1,1]
  v_lshlrev_b32 v10, 16, v123
  v_and_b32 v11, 0xffff0000, v123
  v_pk_fma_f32 v[50:51], v[10:11], v[148:149], v[50:51] op_sel:[0,1,0] op_sel_hi:[1,1,1]
  v_lshlrev_b32 v8, 16, v124
  v_and_b32 v9, 0xffff0000, v124
  v_pk_fma_f32 v[44:45], v[8:9], v[150:151], v[44:45] op_sel_hi:[1,0,1]
  v_lshlrev_b32 v10, 16, v125
  v_and_b32 v11, 0xffff0000, v125
  v_pk_fma_f32 v[46:47], v[10:11], v[150:151], v[46:47] op_sel_hi:[1,0,1]
  v_lshlrev_b32 v8, 16, v126
  v_and_b32 v9, 0xffff0000, v126
  v_pk_fma_f32 v[48:49], v[8:9], v[150:151], v[48:49] op_sel_hi:[1,0,1]
  v_lshlrev_b32 v10, 16, v127
  v_and_b32 v11, 0xffff0000, v127
  v_pk_fma_f32 v[50:51], v[10:11], v[150:151], v[50:51] op_sel_hi:[1,0,1]
  v_lshlrev_b32 v8, 16, v128
  v_and_b32 v9, 0xffff0000, v128
  v_pk_fma_f32 v[44:45], v[8:9], v[150:151], v[44:45] op_sel:[0,1,0] op_sel_hi:[1,1,1]
  v_lshlrev_b32 v10, 16, v129
  v_and_b32 v11, 0xffff0000, v129
  v_pk_fma_f32 v[46:47], v[10:11], v[150:151], v[46:47] op_sel:[0,1,0] op_sel_hi:[1,1,1]
  v_lshlrev_b32 v8, 16, v130
  v_and_b32 v9, 0xffff0000, v130
  v_pk_fma_f32 v[48:49], v[8:9], v[150:151], v[48:49] op_sel:[0,1,0] op_sel_hi:[1,1,1]
  v_lshlrev_b32 v10, 16, v131
  v_and_b32 v11, 0xffff0000, v131
  v_pk_fma_f32 v[50:51], v[10:11], v[150:151], v[50:51] op_sel:[0,1,0] op_sel_hi:[1,1,1]
  v_lshlrev_b32 v8, 16, v132
  v_and_b32 v9, 0xffff0000, v132
  v_pk_fma_f32 v[44:45], v[8:9], v[152:153], v[44:45] op_sel_hi:[1,0,1]
  v_lshlrev_b32 v10, 16, v133
  v_and_b32 v11, 0xffff0000, v133
  v_pk_fma_f32 v[46:47], v[10:11], v[152:153], v[46:47] op_sel_hi:[1,0,1]
  v_lshlrev_b32 v8, 16, v134
  v_and_b32 v9, 0xffff0000, v134
  v_pk_fma_f32 v[48:49], v[8:9], v[152:153], v[48:49] op_sel_hi:[1,0,1]
  v_lshlrev_b32 v10, 16, v135
  v_and_b32 v11, 0xffff0000, v135
  v_pk_fma_f32 v[50:51], v[10:11], v[152:153], v[50:51] op_sel_hi:[1,0,1]
  v_lshlrev_b32 v8, 16, v136
  v_and_b32 v9, 0xffff0000, v136
  v_pk_fma_f32 v[44:45], v[8:9], v[152:153], v[44:45] op_sel:[0,1,0] op_sel_hi:[1,1,1]
  v_lshlrev_b32 v10, 16, v137
  v_and_b32 v11, 0xffff0000, v137
  v_pk_fma_f32 v[46:47], v[10:11], v[152:153], v[46:47] op_sel:[0,1,0] op_sel_hi:[1,1,1]
  v_lshlrev_b32 v8, 16, v138
  v_and_b32 v9, 0xffff0000, v138
  v_pk_fma_f32 v[48:49], v[8:9], v[152:153], v[48:49] op_sel:[0,1,0] op_sel_hi:[1,1,1]
  v_lshlrev_b32 v10, 16, v139
  v_and_b32 v11, 0xffff0000, v139
  v_pk_fma_f32 v[50:51], v[10:11], v[152:153], v[50:51] op_sel:[0,1,0] op_sel_hi:[1,1,1]
  v_lshlrev_b32 v8, 16, v140
  v_and_b32 v9, 0xffff0000, v140
  v_pk_fma_f32 v[44:45], v[8:9], v[154:155], v[44:45] op_sel_hi:[1,0,1]
  v_lshlrev_b32 v10, 16, v141
  v_and_b32 v11, 0xffff0000, v141
  v_pk_fma_f32 v[46:47], v[10:11], v[154:155], v[46:47] op_sel_hi:[1,0,1]
  v_lshlrev_b32 v8, 16, v142
  v_and_b32 v9, 0xffff0000, v142
  v_pk_fma_f32 v[48:49], v[8:9], v[154:155], v[48:49] op_sel_hi:[1,0,1]
  v_lshlrev_b32 v10, 16, v143
  v_and_b32 v11, 0xffff0000, v143
  v_pk_fma_f32 v[50:51], v[10:11], v[154:155], v[50:51] op_sel_hi:[1,0,1]
  v_lshlrev_b32 v8, 16, v144
  v_and_b32 v9, 0xffff0000, v144
  v_pk_fma_f32 v[44:45], v[8:9], v[154:155], v[44:45] op_sel:[0,1,0] op_sel_hi:[1,1,1]
  v_lshlrev_b32 v10, 16, v145
  v_and_b32 v11, 0xffff0000, v145
  v_pk_fma_f32 v[46:47], v[10:11], v[154:155], v[46:47] op_sel:[0,1,0] op_sel_hi:[1,1,1]
  v_lshlrev_b32 v8, 16, v146
  v_and_b32 v9, 0xffff0000, v146
  v_pk_fma_f32 v[48:49], v[8:9], v[154:155], v[48:49] op_sel:[0,1,0] op_sel_hi:[1,1,1]
  v_lshlrev_b32 v10, 16, v147
  v_and_b32 v11, 0xffff0000, v147
  v_pk_fma_f32 v[50:51], v[10:11], v[154:155], v[50:51] op_sel:[0,1,0] op_sel_hi:[1,1,1]
  v_permlane32_swap_b32 v44, v48
  v_permlane32_swap_b32 v45, v49
  v_permlane32_swap_b32 v46, v50
  v_permlane32_swap_b32 v47, v51
  v_add_f32 v44, v44, v48
  v_add_f32 v45, v45, v49
  v_add_f32 v46, v46, v50
  v_add_f32 v47, v47, v51
  s_nop 0
  v_permlane16_swap_b32 v44, v46
  v_permlane16_swap_b32 v45, v47
  v_add_f32 v44, v44, v46
  v_add_f32 v45, v45, v47
  s_nop 0
  v_add_f32_dpp v44, v44, v44 row_ror:8 row_mask:0xf bank_mask:0xf
  v_add_f32_dpp v45, v45, v45 row_ror:8 row_mask:0xf bank_mask:0xf
  ds_write_b64 v167, v[44:45] offset:4352
  v_mov_b32 v10, 0
  v_mov_b32 v11, 1
  s_mov_b64 exec, 1
  ds_add_rtn_u32 v11, v10, v11 offset:4
  s_waitcnt lgkmcnt(0)
  s_mov_b64 exec, -1
  v_readfirstlane_b32 s4, v11
  s_nop 0
  s_cmp_lg_u32 s4, 3
  s_cbranch_scc1 L_pubM2_13
  ds_read_b32 v44, v4 offset:4352
  ds_read_b32 v45, v4 offset:4608
  ds_read_b32 v46, v4 offset:4864
  ds_read_b32 v47, v4 offset:5120
  s_mov_b32 s14, 65536
  v_mov_b32 v10, 0
L_lwclr_14:
  ds_read_b32 v11, v10 offset:20
  s_waitcnt lgkmcnt(0)
  v_readfirstlane_b32 s15, v11
  s_nop 0
  s_cmp_ge_u32 s15, 4
  s_cbranch_scc1 L_lwxclr_15
  s_sleep 1
  s_sub_u32 s14, s14, 1
  s_cmp_eq_u32 s14, 0
  s_cbranch_scc0 L_lwclr_14
L_lwxclr_15:
  s_waitcnt lgkmcnt(0)
  v_add_f32 v44, v44, v45
  v_add_f32 v46, v46, v47
  v_add_f32 v44, v44, v46
  v_min_u32 v44, 0xfffffffe, v44
  buffer_store_dword v44, v4, s[48:51], s12 offen sc1
  s_nop 0
L_pubM2_13:
  v_and_b32 v17, 124, v4
  s_mov_b32 s14, 65536
  v_mov_b32 v9, 0
  s_mov_b64 exec, 1
L_go2_16:
  buffer_load_dword v8, v9, s[68:71], 0 offen offset:128 sc1
  s_waitcnt vmcnt(0)
  v_cmp_ne_u32 vcc, 1, v8
  s_cbranch_vccz L_gox2_17
  s_sleep 16
  s_sub_u32 s14, s14, 1
  s_cmp_eq_u32 s14, 0
  s_cbranch_scc0 L_go2_16
L_gox2_17:
  s_mov_b64 exec, -1
  s_cmp_eq_u32 s88, 0
  s_cbranch_scc1 L_sw2PM_20
  s_mov_b32 s88, 0
  v_add_u32 v10, 1, v6
  v_bfi_b32 v10, 3, v10, v6
  buffer_store_dword v10, v4, s[48:51], s10 offen sc1
L_sw2PM_20:
  s_cmp_eq_u32 s89, 0
  s_cbranch_scc1 L_sw2PQ_21
  s_mov_b32 s89, 0
  v_add_u32 v10, 1, v7
  v_bfi_b32 v10, 3, v10, v7
  buffer_store_dword v10, v4, s[48:51], s11 offen sc1
L_sw2PQ_21:
  s_mov_b32 s80, s32
  s_mov_b32 s81, s33
  s_mov_b32 s82, 0x700000
  s_mov_b32 s83, 0x20000
  s_mov_b32 s84, s30
  s_mov_b32 s85, s31
  s_mov_b32 s86, 0x1c00
  s_mov_b32 s87, 0x20000
  s_mov_b32 s88, s34
  s_mov_b32 s89, s35
  s_mov_b32 s90, 0x800
  s_mov_b32 s91, 0x20000
  s_mov_b32 s92, s40
  s_mov_b32 s93, s41
  s_mov_b32 s94, 0x800
  s_mov_b32 s95, 0x20000
  v_lshrrev_b32 v8, 5, v3
  v_bfe_u32 v9, v3, 2, 3
  v_and_b32 v10, 3, v3
  v_lshlrev_b32 v9, 3, v9
  v_lshl_add_u32 v9, v10, 1, v9
  v_lshrrev_b32 v10, 2, v8
  v_add_u32 v9, v9, v10
  v_lshlrev_b32 v9, 12, v9
  v_and_b32 v8, 3, v8
  v_lshl_add_u32 v6, v8, 4, v9
  v_lshrrev_b32 v8, 3, v3
  v_lshlrev_b32 v8, 15, v8
  v_and_b32 v7, 7, v3
  v_lshl_add_u32 v7, v7, 4, v8
  s_lshr_b32 s7, s2, 6
  s_lshl_b32 s7, s7, 18
  s_and_b32 s4, s2, 63
  s_lshl_b32 s4, s4, 6
  s_add_u32 s7, s7, s4
  s_add_u32 s7, s7, 1048576
  s_lshl_b32 s4, s2, 7
  s_add_u32 s8, s4, 2097152
  s_add_u32 s9, s4, 3145728
  s_cmp_lt_u32 s2, 224
  s_cbranch_scc1 L_pre_worker
  s_sub_u32 s15, s2, 224
  s_lshr_b32 s4, s15, 1
  s_lshl_b32 s4, s4, 10
  s_and_b32 s14, s15, 1
  s_lshl_b32 s14, s14, 7
  s_add_u32 s4, s4, s14
  s_add_u32 s16, s4, 262144
  s_add_u32 s17, s16, 16384
  s_add_u32 s18, s17, 16384
  s_add_u32 s19, s18, 16384
  s_lshl_b32 s20, s15, 6
  v_lshrrev_b32 v10, 1, v17
  buffer_load_ushort v150, v10, s[64:67], s20 offen
  buffer_load_ushort v151, v10, s[88:91], s20 offen
  s_mov_b32 s14, 65536
L_gM2P_22:
  buffer_load_dword v116, v17, s[48:51], s16 offen offset:0 sc1
  buffer_load_dword v117, v17, s[48:51], s16 offen offset:256 sc1
  buffer_load_dword v118, v17, s[48:51], s16 offen offset:512 sc1
  buffer_load_dword v119, v17, s[48:51], s16 offen offset:768 sc1
  buffer_load_dword v120, v17, s[48:51], s17 offen offset:0 sc1
  buffer_load_dword v121, v17, s[48:51], s17 offen offset:256 sc1
  buffer_load_dword v122, v17, s[48:51], s17 offen offset:512 sc1
  buffer_load_dword v123, v17, s[48:51], s17 offen offset:768 sc1
  buffer_load_dword v124, v17, s[48:51], s18 offen offset:0 sc1
  buffer_load_dword v125, v17, s[48:51], s18 offen offset:256 sc1
  buffer_load_dword v126, v17, s[48:51], s18 offen offset:512 sc1
  buffer_load_dword v127, v17, s[48:51], s18 offen offset:768 sc1
  buffer_load_dword v128, v17, s[48:51], s19 offen offset:0 sc1
  buffer_load_dword v129, v17, s[48:51], s19 offen offset:256 sc1
  buffer_load_dword v130, v17, s[48:51], s19 offen offset:512 sc1
  buffer_load_dword v131, v17, s[48:51], s19 offen offset:768 sc1
  s_waitcnt vmcnt(0)
  v_max3_u32 v8, v116, v117, v118
  v_max3_u32 v8, v8, v119, v120
  v_max3_u32 v8, v8, v121, v122
  v_max_u32 v8, v8, v123
  v_max3_u32 v9, v124, v125, v126
  v_max3_u32 v9, v9, v127, v128
  v_max3_u32 v9, v9, v129, v130
  v_max_u32 v9, v9, v131
  v_max_u32 v8, v8, v9
  v_cmp_eq_u32 vcc, -1, v8
  s_cbranch_vccz L_gxM2P_23
  s_mov_b64 exec, vcc
  s_sleep 8
  s_sub_u32 s14, s14, 1
  s_cmp_eq_u32 s14, 0
  s_cbranch_scc0 L_gM2P_22
L_gxM2P_23:
  s_mov_b64 exec, -1
  v_add_f32 v116, v116, v117
  v_add_f32 v118, v118, v119
  v_add_f32 v116, v116, v118
  v_add_f32 v120, v120, v121
  v_add_f32 v122, v122, v123
  v_add_f32 v120, v120, v122
  v_add_f32 v124, v124, v125
  v_add_f32 v126, v126, v127
  v_add_f32 v124, v124, v126
  v_add_f32 v128, v128, v129
  v_add_f32 v130, v130, v131
  v_add_f32 v128, v128, v130
  v_cvt_pk_bf16_f32 v8, v116, v128
  v_lshlrev_b32 v116, 16, v8
  v_and_b32 v128, 0xffff0000, v8
  v_cvt_pk_bf16_f32 v124, v124, v124
  v_and_b32 v124, 0xffff0000, v124
  v_mov_b32 v148, v116
  v_mov_b32 v149, v128
  v_add_f32 v124, 1.0, v124
  v_cvt_pk_bf16_f32 v8, v124, v120
  v_min_u32 v8, 0xfffffffe, v8
  v_lshlrev_b32 v150, 16, v150
  v_lshlrev_b32 v151, 16, v151
  s_lshl_b32 s4, s15, 7
  s_add_u32 s4, s4, 344064
  s_cmp_lg_u32 s3, 3
  s_cbranch_scc1 L_pre_done
  buffer_store_dword v8, v17, s[48:51], s4 offen sc1
  s_branch L_pre_done
L_pre_worker:
  v_lshrrev_b32 v10, 1, v16
  s_lshl_b32 s4, s37, 5
  buffer_load_ushort v156, v10, s[84:87], s4 offen
  v_lshlrev_b32 v10, 2, v3
  s_add_u32 s4, s2, 0
  s_and_b32 s4, s4, 3
  s_lshl_b32 s42, s4, 10
  s_add_u32 s42, s42, 348160
  s_add_u32 s4, s2, 1
  s_and_b32 s4, s4, 3
  s_lshl_b32 s43, s4, 10
  s_add_u32 s43, s43, 348160
  s_add_u32 s4, s2, 2
  s_and_b32 s4, s4, 3
  s_lshl_b32 s44, s4, 10
  s_add_u32 s44, s44, 348160
  s_add_u32 s4, s2, 3
  s_and_b32 s4, s4, 3
  s_lshl_b32 s45, s4, 10
  s_add_u32 s45, s45, 348160
  s_waitcnt vmcnt(0)
  v_lshlrev_b32 v156, 16, v156
  s_nop 1
L_pre_done:
  v_lshlrev_b32 v157, 4, v3
  v_add_u32 v158, 0x10000, v157
  v_bfe_u32 v8, v0, 5, 1
  v_bfe_u32 v9, v0, 4, 1
  v_lshl_add_u32 v10, v8, 1, v9
  v_lshl_add_u32 v159, v10, 2, v2
  s_lshl_b32 s4, s3, 7
  v_add_u32 v159, s4, v159
  v_lshlrev_b32 v160, 1, v2
  v_lshl_add_u32 v160, v10, 3, v160
  s_lshl_b32 s4, s3, 8
  v_add_u32 v160, s4, v160
  v_lshlrev_b32 v165, 2, v3
  v_lshlrev_b32 v166, 5, v1
  v_add_u32 v166, s4, v166
  v_lshrrev_b32 v167, 4, v0
  v_lshlrev_b32 v167, 8, v167
  v_add_u32 v167, v167, v16
  s_lshl_b32 s46, s2, 8
  s_add_u32 s46, s46, 393216
  s_and_b32 s4, s2, 0xfc
  s_lshl_b32 s47, s4, 8
  s_and_b32 s4, s2, 3
  s_lshl_b32 s4, s4, 6
  s_add_u32 s47, s47, s4
  s_add_u32 s47, s47, 393216
  v_lshlrev_b32 v161, 4, v8
  s_lshl_b32 s4, s3, 2
  v_add_u32 v161, s4, v161
  v_lshrrev_b32 v162, 1, v17
  v_lshrrev_b32 v163, 2, v0
  v_lshlrev_b32 v163, 6, v163
  v_lshrrev_b32 v164, 2, v2
  s_lshl_b32 s10, s2, 12
  s_add_u32 s10, s10, 1048576
  s_sub_u32 s4, s2, 224
  s_and_b32 s4, s4, 31
  s_lshl_b32 s14, s4, 15
  s_lshl_b32 s15, s3, 13
  s_add_u32 s11, s14, s15
  s_add_u32 s11, s11, 2097152
  s_mul_i32 s15, s3, 7168
  s_add_u32 s12, s14, s15
  s_add_u32 s12, s12, 3145728
  s_lshl_b32 s32, s4, 7
  s_add_u32 s32, s32, 348160
  s_lshl_b32 s33, s4, 6
  s_add_u32 s34, s11, 4096
  s_add_u32 s35, s12, 4096
  s_mov_b32 s36, 348160
  s_lshl_b32 s39, s5, 12
  s_bfe_u32 s4, s2, 0x30003
  s_lshl_b32 s4, s4, 3
  s_add_u32 s39, s39, s4
  s_add_u32 s39, s39, 327680
  s_mov_b32 s40, 0xf0f0f0f0
  s_mov_b32 s41, 0xf0f0f0f0
  s_cmp_lg_u32 s3, 0
  s_cbranch_scc1 L_nostats
  s_mov_b32 s14, 65536
  v_mov_b32 v8, 0
L_lwst_24:
  ds_read_b32 v9, v8 offset:16
  s_waitcnt lgkmcnt(0)
  v_readfirstlane_b32 s15, v9
  s_nop 0
  s_cmp_ge_u32 s15, 8
  s_cbranch_scc1 L_lwxst_25
  s_sleep 2
  s_sub_u32 s14, s14, 1
  s_cmp_eq_u32 s14, 0
  s_cbranch_scc0 L_lwst_24
L_lwxst_25:
  v_lshlrev_b32 v8, 1, v2
  v_lshl_add_u32 v8, v1, 2, v8
  ds_read_b32 v152, v8 offset:6400
  ds_read_b32 v153, v8 offset:6656
  s_waitcnt lgkmcnt(0)
  v_mov_b32 v154, v152
  s_nop 1
  v_max_f32_dpp v154, v154, v154 row_ror:8 row_mask:0xf bank_mask:0xf
  v_mov_b32 v8, v154
  s_nop 1
  v_permlane16_swap_b32 v154, v8
  v_max_f32 v154, v154, v8
  v_mov_b32 v8, v154
  s_nop 1
  v_permlane32_swap_b32 v154, v8
  v_max_f32 v154, v154, v8
  v_sub_f32 v9, v152, v154
  v_mul_f32 v9, s101, v9
  v_exp_f32 v9, v9
  s_nop 0
  v_mul_f32 v155, v153, v9
  s_nop 1
  v_add_f32_dpp v155, v155, v155 row_ror:8 row_mask:0xf bank_mask:0xf
  v_mov_b32 v8, v155
  s_nop 1
  v_permlane16_swap_b32 v155, v8
  v_add_f32 v155, v155, v8
  v_mov_b32 v8, v155
  s_nop 1
  v_permlane32_swap_b32 v155, v8
  v_add_f32 v155, v155, v8
  v_min_u32 v154, 0xfffffffe, v154
  v_min_u32 v155, 0xfffffffe, v155
  v_lshrrev_b32 v8, 1, v2
  buffer_store_dwordx2 v[154:155], v8, s[48:51], s13 offen sc1
  s_nop 0
L_nostats:
  s_lshr_b32 s4, s2, 3
  s_lshl_b32 s4, s4, 7
  s_bfe_u32 s14, s2, 0x20001
  s_lshl_b32 s14, s14, 5
  s_add_u32 s4, s4, s14
  s_and_b32 s14, s2, 1
  s_lshl_b32 s14, s14, 2
  s_add_u32 s4, s4, s14
  s_lshl_b32 s38, s4, 11
  s_and_b32 s4, s2, 3
  s_lshl_b32 s4, s4, 8
  s_lshl_b32 s14, s3, 6
  s_add_u32 s4, s4, s14
  s_mul_i32 s4, s4, 7168
  s_lshr_b32 s14, s2, 2
  s_lshl_b32 s14, s14, 7
  s_add_u32 s99, s4, s14
  s_cmp_ge_u32 s2, 224
  s_cselect_b32 s36, 1, 0
  s_barrier
  ds_read_b128 v[84:87], v157 offset:9216
  ds_read_b128 v[88:91], v157 offset:25600
  ds_read_b128 v[92:95], v157 offset:41984
  ds_read_b128 v[96:99], v157 offset:58368
  ds_read_b128 v[100:103], v158 offset:9216
  ds_read_b128 v[104:107], v158 offset:25600
  ds_read_b128 v[108:111], v158 offset:41984
  ds_read_b128 v[112:115], v158 offset:58368
  s_waitcnt lgkmcnt(6)
  v_pk_add_f32 v[84:85], v[84:85], v[88:89]
  v_pk_add_f32 v[86:87], v[86:87], v[90:91]
  s_waitcnt lgkmcnt(4)
  v_pk_add_f32 v[92:93], v[92:93], v[96:97]
  v_pk_add_f32 v[94:95], v[94:95], v[98:99]
  s_waitcnt lgkmcnt(2)
  v_pk_add_f32 v[100:101], v[100:101], v[104:105]
  v_pk_add_f32 v[102:103], v[102:103], v[106:107]
  s_waitcnt lgkmcnt(0)
  v_pk_add_f32 v[108:109], v[108:109], v[112:113]
  v_pk_add_f32 v[110:111], v[110:111], v[114:115]
  v_pk_add_f32 v[84:85], v[84:85], v[92:93]
  v_pk_add_f32 v[86:87], v[86:87], v[94:95]
  v_pk_add_f32 v[100:101], v[100:101], v[108:109]
  v_pk_add_f32 v[102:103], v[102:103], v[110:111]
  v_pk_add_f32 v[84:85], v[84:85], v[100:101]
  v_pk_add_f32 v[86:87], v[86:87], v[102:103]
  v_min_u32 v84, 0xfffffffe, v84
  v_min_u32 v85, 0xfffffffe, v85
  v_min_u32 v86, 0xfffffffe, v86
  v_min_u32 v87, 0xfffffffe, v87
  buffer_store_dwordx4 v[84:87], v6, s[48:51], s7 offen sc1
  s_add_u32 s14, s38, 0
  buffer_load_dwordx2 v[52:53], v18, s[72:75], s14 offen nt
  s_add_u32 s14, s38, 16384
  buffer_load_dwordx2 v[54:55], v18, s[72:75], s14 offen nt
  s_add_u32 s14, s38, 32768
  buffer_load_dwordx2 v[56:57], v18, s[72:75], s14 offen nt
  s_add_u32 s14, s38, 49152
  buffer_load_dwordx2 v[58:59], v18, s[72:75], s14 offen nt
  s_add_u32 s14, s38, 2048
  buffer_load_dwordx2 v[60:61], v18, s[72:75], s14 offen nt
  s_add_u32 s14, s38, 18432
  buffer_load_dwordx2 v[62:63], v18, s[72:75], s14 offen nt
  s_add_u32 s14, s38, 34816
  buffer_load_dwordx2 v[64:65], v18, s[72:75], s14 offen nt
  s_add_u32 s14, s38, 51200
  buffer_load_dwordx2 v[66:67], v18, s[72:75], s14 offen nt
  s_add_u32 s14, s38, 4096
  buffer_load_dwordx2 v[68:69], v18, s[72:75], s14 offen nt
  s_add_u32 s14, s38, 20480
  buffer_load_dwordx2 v[70:71], v18, s[72:75], s14 offen nt
  s_add_u32 s14, s38, 36864
  buffer_load_dwordx2 v[72:73], v18, s[72:75], s14 offen nt
  s_add_u32 s14, s38, 53248
  buffer_load_dwordx2 v[74:75], v18, s[72:75], s14 offen nt
  s_add_u32 s14, s38, 6144
  buffer_load_dwordx2 v[76:77], v18, s[72:75], s14 offen nt
  s_add_u32 s14, s38, 22528
  buffer_load_dwordx2 v[78:79], v18, s[72:75], s14 offen nt
  s_add_u32 s14, s38, 38912
  buffer_load_dwordx2 v[80:81], v18, s[72:75], s14 offen nt
  s_add_u32 s14, s38, 55296
  buffer_load_dwordx2 v[82:83], v18, s[72:75], s14 offen nt
  s_mov_b32 s14, 65536
  buffer_load_dwordx2 v[88:89], v163, s[48:51], s39 offen offset:0 sc1
  buffer_load_dwordx2 v[90:91], v163, s[48:51], s39 offen offset:1024 sc1
  buffer_load_dwordx2 v[92:93], v163, s[48:51], s39 offen offset:2048 sc1
  buffer_load_dwordx2 v[94:95], v163, s[48:51], s39 offen offset:3072 sc1
  buffer_load_dwordx4 v[100:103], v5, s[48:51], s10 offen offset:0 sc1
  buffer_load_dwordx4 v[104:107], v5, s[48:51], s10 offen offset:1024 sc1
  buffer_load_dwordx4 v[108:111], v5, s[48:51], s10 offen offset:2048 sc1
  buffer_load_dwordx4 v[112:115], v5, s[48:51], s10 offen offset:3072 sc1
  s_waitcnt vmcnt(8)
  v_lshlrev_b32 v20, 16, v52
  v_and_b32 v21, 0xffff0000, v52
  v_lshlrev_b32 v22, 16, v53
  v_and_b32 v23, 0xffff0000, v53
  v_lshlrev_b32 v24, 16, v54
  v_and_b32 v25, 0xffff0000, v54
  v_lshlrev_b32 v26, 16, v55
  v_and_b32 v27, 0xffff0000, v55
  v_lshlrev_b32 v28, 16, v56
  v_and_b32 v29, 0xffff0000, v56
  v_lshlrev_b32 v30, 16, v57
  v_and_b32 v31, 0xffff0000, v57
  v_lshlrev_b32 v32, 16, v58
  v_and_b32 v33, 0xffff0000, v58
  v_lshlrev_b32 v34, 16, v59
  v_and_b32 v35, 0xffff0000, v59
  v_lshlrev_b32 v36, 16, v60
  v_and_b32 v37, 0xffff0000, v60
  v_lshlrev_b32 v38, 16, v61
  v_and_b32 v39, 0xffff0000, v61
  v_lshlrev_b32 v40, 16, v62
  v_and_b32 v41, 0xffff0000, v62
  v_lshlrev_b32 v42, 16, v63
  v_and_b32 v43, 0xffff0000, v63
  v_lshlrev_b32 v44, 16, v64
  v_and_b32 v45, 0xffff0000, v64
  v_lshlrev_b32 v46, 16, v65
  v_and_b32 v47, 0xffff0000, v65
  v_lshlrev_b32 v48, 16, v66
  v_and_b32 v49, 0xffff0000, v66
  v_lshlrev_b32 v50, 16, v67
  v_and_b32 v51, 0xffff0000, v67
  v_lshlrev_b32 v52, 16, v68
  v_and_b32 v53, 0xffff0000, v68
  v_lshlrev_b32 v54, 16, v69
  v_and_b32 v55, 0xffff0000, v69
  v_lshlrev_b32 v56, 16, v70
  v_and_b32 v57, 0xffff0000, v70
  v_lshlrev_b32 v58, 16, v71
  v_and_b32 v59, 0xffff0000, v71
  v_lshlrev_b32 v60, 16, v72
  v_and_b32 v61, 0xffff0000, v72
  v_lshlrev_b32 v62, 16, v73
  v_and_b32 v63, 0xffff0000, v73
  v_lshlrev_b32 v64, 16, v74
  v_and_b32 v65, 0xffff0000, v74
  v_lshlrev_b32 v66, 16, v75
  v_and_b32 v67, 0xffff0000, v75
  v_lshlrev_b32 v68, 16, v76
  v_and_b32 v69, 0xffff0000, v76
  v_lshlrev_b32 v70, 16, v77
  v_and_b32 v71, 0xffff0000, v77
  v_lshlrev_b32 v72, 16, v78
  v_and_b32 v73, 0xffff0000, v78
  v_lshlrev_b32 v74, 16, v79
  v_and_b32 v75, 0xffff0000, v79
  v_lshlrev_b32 v76, 16, v80
  v_and_b32 v77, 0xffff0000, v80
  v_lshlrev_b32 v78, 16, v81
  v_and_b32 v79, 0xffff0000, v81
  v_lshlrev_b32 v80, 16, v82
  v_and_b32 v81, 0xffff0000, v82
  v_lshlrev_b32 v82, 16, v83
  v_and_b32 v83, 0xffff0000, v83
  s_nop 1
  s_branch L_gmOP_28
L_gOP_26:
  buffer_load_dwordx2 v[88:89], v163, s[48:51], s39 offen offset:0 sc1
  buffer_load_dwordx2 v[90:91], v163, s[48:51], s39 offen offset:1024 sc1
  buffer_load_dwordx2 v[92:93], v163, s[48:51], s39 offen offset:2048 sc1
  buffer_load_dwordx2 v[94:95], v163, s[48:51], s39 offen offset:3072 sc1
  buffer_load_dwordx4 v[100:103], v5, s[48:51], s10 offen offset:0 sc1
  buffer_load_dwordx4 v[104:107], v5, s[48:51], s10 offen offset:1024 sc1
  buffer_load_dwordx4 v[108:111], v5, s[48:51], s10 offen offset:2048 sc1
  buffer_load_dwordx4 v[112:115], v5, s[48:51], s10 offen offset:3072 sc1
L_gmOP_28:
  s_waitcnt vmcnt(0)
  v_max3_u32 v8, v88, v89, v90
  v_max3_u32 v8, v8, v91, v92
  v_max3_u32 v8, v8, v93, v94
  v_max3_u32 v8, v8, v95, v100
  v_max3_u32 v8, v8, v101, v102
  v_max_u32 v8, v8, v103
  v_max3_u32 v9, v104, v105, v106
  v_max3_u32 v9, v9, v107, v108
  v_max3_u32 v9, v9, v109, v110
  v_max3_u32 v9, v9, v111, v112
  v_max3_u32 v9, v9, v113, v114
  v_max_u32 v9, v9, v115
  v_max_u32 v8, v8, v9
  v_cmp_eq_u32 vcc, -1, v8
  s_cbranch_vccz L_gxOP_27
  s_cmp_eq_u32 s36, 1
  s_cbranch_scc1 L_ew1_29
  s_bcnt1_i32_b64 s4, vcc
  s_mov_b32 s36, 2
  s_cmp_le_u32 s4, 16
  s_cbranch_scc1 L_ew1_29
  s_mov_b32 s36, 1
  s_mov_b32 s4, s99
  buffer_load_dwordx4 v[116:119], v19, s[76:79], s4 offen nt
  s_add_u32 s4, s4, 7168
  buffer_load_dwordx4 v[120:123], v19, s[76:79], s4 offen nt
  s_add_u32 s4, s4, 7168
  buffer_load_dwordx4 v[124:127], v19, s[76:79], s4 offen nt
  s_add_u32 s4, s4, 7168
  buffer_load_dwordx4 v[128:131], v19, s[76:79], s4 offen nt
  s_add_u32 s4, s4, 7168
  buffer_load_dwordx4 v[132:135], v19, s[76:79], s4 offen nt
  s_add_u32 s4, s4, 7168
  buffer_load_dwordx4 v[136:139], v19, s[76:79], s4 offen nt
  s_add_u32 s4, s4, 7168
  buffer_load_dwordx4 v[140:143], v19, s[76:79], s4 offen nt
  s_add_u32 s4, s4, 7168
  buffer_load_dwordx4 v[144:147], v19, s[76:79], s4 offen nt
L_ew1_29:
  s_mov_b64 exec, vcc
  s_sub_u32 s14, s14, 1
  s_cmp_eq_u32 s14, 0
  s_cbranch_scc0 L_gOP_26
L_gxOP_27:
  s_mov_b64 exec, -1
  v_max3_f32 v96, v88, v90, v92
  v_max_f32 v96, v96, v94
  s_nop 1
  v_max_f32_dpp v96, v96, v96 row_ror:4 row_mask:0xf bank_mask:0xf
  s_nop 1
  v_max_f32_dpp v96, v96, v96 row_ror:8 row_mask:0xf bank_mask:0xf
  v_mov_b32 v8, v96
  s_nop 1
  v_permlane16_swap_b32 v96, v8
  v_max_f32 v96, v96, v8
  v_mov_b32 v8, v96
  s_nop 1
  v_permlane32_swap_b32 v96, v8
  v_max_f32 v96, v96, v8
  v_sub_f32 v88, v88, v96
  v_sub_f32 v90, v90, v96
  v_sub_f32 v92, v92, v96
  v_sub_f32 v94, v94, v96
  v_mul_f32 v88, s101, v88
  v_mul_f32 v90, s101, v90
  v_mul_f32 v92, s101, v92
  v_mul_f32 v94, s101, v94
  v_exp_f32 v88, v88
  v_exp_f32 v90, v90
  v_exp_f32 v92, v92
  v_exp_f32 v94, v94
  v_mul_f32 v97, v88, v89
  v_fmac_f32 v97, v90, v91
  v_fmac_f32 v97, v92, v93
  v_fmac_f32 v97, v94, v95
  v_pk_mul_f32 v[100:101], v[100:101], v[88:89] op_sel_hi:[1,0]
  v_pk_mul_f32 v[102:103], v[102:103], v[88:89] op_sel_hi:[1,0]
  v_pk_fma_f32 v[100:101], v[104:105], v[90:91], v[100:101] op_sel_hi:[1,0,1]
  v_pk_fma_f32 v[102:103], v[106:107], v[90:91], v[102:103] op_sel_hi:[1,0,1]
  v_pk_fma_f32 v[100:101], v[108:109], v[92:93], v[100:101] op_sel_hi:[1,0,1]
  v_pk_fma_f32 v[102:103], v[110:111], v[92:93], v[102:103] op_sel_hi:[1,0,1]
  v_pk_fma_f32 v[100:101], v[112:113], v[94:95], v[100:101] op_sel_hi:[1,0,1]
  v_pk_fma_f32 v[102:103], v[114:115], v[94:95], v[102:103] op_sel_hi:[1,0,1]
  v_add_f32_dpp v97, v97, v97 row_ror:4 row_mask:0xf bank_mask:0xf
  s_nop 0
  v_permlane32_swap_b32 v100, v102
  v_permlane32_swap_b32 v101, v103
  v_add_f32_dpp v97, v97, v97 row_ror:8 row_mask:0xf bank_mask:0xf
  v_add_f32 v100, v100, v102
  v_add_f32 v101, v101, v103
  v_mov_b32 v8, v97
  s_nop 0
  v_permlane16_swap_b32 v100, v101
  v_permlane16_swap_b32 v97, v8
  v_add_f32 v100, v100, v101
  v_add_f32 v97, v97, v8
  v_mov_b32 v8, v97
  v_add_f32_dpp v100, v100, v100 row_ror:8 row_mask:0xf bank_mask:0xf
  s_nop 0
  v_permlane32_swap_b32 v97, v8
  v_add_f32 v97, v97, v8
  v_add_f32_dpp v100, v100, v100 row_ror:4 row_mask:0xf bank_mask:0xf
  v_rcp_f32 v97, v97
  s_nop 0
  v_mul_f32 v100, v100, v97
  v_cvt_pk_bf16_f32 v100, v100, v100
  v_and_b32 v100, 0xffff0000, v100
  s_nop 0
  v_readlane_b32 s16, v100, 0
  v_readlane_b32 s17, v100, 16
  v_readlane_b32 s18, v100, 32
  v_readlane_b32 s19, v100, 48
  v_readlane_b32 s20, v100, 1
  v_readlane_b32 s21, v100, 17
  v_readlane_b32 s22, v100, 33
  v_readlane_b32 s23, v100, 49
  v_readlane_b32 s24, v100, 2
  v_readlane_b32 s25, v100, 18
  v_readlane_b32 s26, v100, 34
  v_readlane_b32 s27, v100, 50
  v_readlane_b32 s28, v100, 3
  v_readlane_b32 s29, v100, 19
  v_readlane_b32 s30, v100, 35
  v_readlane_b32 s31, v100, 51
  v_pk_mul_f32 v[152:153], v[20:21], s[16:17] op_sel_hi:[1,0]
  v_pk_mul_f32 v[154:155], v[22:23], s[16:17] op_sel_hi:[1,0]
  v_pk_mul_f32 v[8:9], v[24:25], s[16:17] op_sel:[0,1] op_sel_hi:[1,1]
  v_pk_mul_f32 v[10:11], v[26:27], s[16:17] op_sel:[0,1] op_sel_hi:[1,1]
  v_pk_fma_f32 v[152:153], v[28:29], s[18:19], v[152:153] op_sel_hi:[1,0,1]
  v_pk_fma_f32 v[154:155], v[30:31], s[18:19], v[154:155] op_sel_hi:[1,0,1]
  v_pk_fma_f32 v[8:9], v[32:33], s[18:19], v[8:9] op_sel:[0,1,0] op_sel_hi:[1,1,1]
  v_pk_fma_f32 v[10:11], v[34:35], s[18:19], v[10:11] op_sel:[0,1,0] op_sel_hi:[1,1,1]
  v_pk_fma_f32 v[152:153], v[36:37], s[20:21], v[152:153] op_sel_hi:[1,0,1]
  v_pk_fma_f32 v[154:155], v[38:39], s[20:21], v[154:155] op_sel_hi:[1,0,1]
  v_pk_fma_f32 v[8:9], v[40:41], s[20:21], v[8:9] op_sel:[0,1,0] op_sel_hi:[1,1,1]
  v_pk_fma_f32 v[10:11], v[42:43], s[20:21], v[10:11] op_sel:[0,1,0] op_sel_hi:[1,1,1]
  v_pk_fma_f32 v[152:153], v[44:45], s[22:23], v[152:153] op_sel_hi:[1,0,1]
  v_pk_fma_f32 v[154:155], v[46:47], s[22:23], v[154:155] op_sel_hi:[1,0,1]
  v_pk_fma_f32 v[8:9], v[48:49], s[22:23], v[8:9] op_sel:[0,1,0] op_sel_hi:[1,1,1]
  v_pk_fma_f32 v[10:11], v[50:51], s[22:23], v[10:11] op_sel:[0,1,0] op_sel_hi:[1,1,1]
  v_pk_fma_f32 v[152:153], v[52:53], s[24:25], v[152:153] op_sel_hi:[1,0,1]
  v_pk_fma_f32 v[154:155], v[54:55], s[24:25], v[154:155] op_sel_hi:[1,0,1]
  v_pk_fma_f32 v[8:9], v[56:57], s[24:25], v[8:9] op_sel:[0,1,0] op_sel_hi:[1,1,1]
  v_pk_fma_f32 v[10:11], v[58:59], s[24:25], v[10:11] op_sel:[0,1,0] op_sel_hi:[1,1,1]
  v_pk_fma_f32 v[152:153], v[60:61], s[26:27], v[152:153] op_sel_hi:[1,0,1]
  v_pk_fma_f32 v[154:155], v[62:63], s[26:27], v[154:155] op_sel_hi:[1,0,1]
  v_pk_fma_f32 v[8:9], v[64:65], s[26:27], v[8:9] op_sel:[0,1,0] op_sel_hi:[1,1,1]
  v_pk_fma_f32 v[10:11], v[66:67], s[26:27], v[10:11] op_sel:[0,1,0] op_sel_hi:[1,1,1]
  v_pk_fma_f32 v[152:153], v[68:69], s[28:29], v[152:153] op_sel_hi:[1,0,1]
  v_pk_fma_f32 v[154:155], v[70:71], s[28:29], v[154:155] op_sel_hi:[1,0,1]
  v_pk_fma_f32 v[8:9], v[72:73], s[28:29], v[8:9] op_sel:[0,1,0] op_sel_hi:[1,1,1]
  v_pk_fma_f32 v[10:11], v[74:75], s[28:29], v[10:11] op_sel:[0,1,0] op_sel_hi:[1,1,1]
  v_pk_fma_f32 v[152:153], v[76:77], s[30:31], v[152:153] op_sel_hi:[1,0,1]
  v_pk_fma_f32 v[154:155], v[78:79], s[30:31], v[154:155] op_sel_hi:[1,0,1]
  v_pk_fma_f32 v[8:9], v[80:81], s[30:31], v[8:9] op_sel:[0,1,0] op_sel_hi:[1,1,1]
  v_pk_fma_f32 v[10:11], v[82:83], s[30:31], v[10:11] op_sel:[0,1,0] op_sel_hi:[1,1,1]
  v_pk_add_f32 v[152:153], v[152:153], v[8:9]
  v_pk_add_f32 v[154:155], v[154:155], v[10:11]
  v_min_u32 v152, 0xfffffffe, v152
  v_min_u32 v153, 0xfffffffe, v153
  v_min_u32 v154, 0xfffffffe, v154
  v_min_u32 v155, 0xfffffffe, v155
  buffer_store_dwordx4 v[152:155], v7, s[48:51], s8 offen sc1
  s_cmp_lt_u32 s2, 224
  s_cbranch_scc1 L_t_worker
  s_mov_b32 s14, 65536
L_gXP_30:
  buffer_load_dwordx4 v[20:23], v5, s[48:51], s11 offen offset:0 sc1
  buffer_load_dwordx4 v[24:27], v5, s[48:51], s11 offen offset:1024 sc1
  buffer_load_dwordx4 v[28:31], v5, s[48:51], s11 offen offset:2048 sc1
  buffer_load_dwordx4 v[32:35], v5, s[48:51], s11 offen offset:3072 sc1
  buffer_load_dwordx4 v[36:39], v5, s[48:51], s34 offen offset:0 sc1
  buffer_load_dwordx4 v[40:43], v5, s[48:51], s34 offen offset:1024 sc1
  buffer_load_dwordx4 v[44:47], v5, s[48:51], s34 offen offset:2048 sc1
  buffer_load_dwordx4 v[48:51], v5, s[48:51], s34 offen offset:3072 sc1
  s_waitcnt vmcnt(0)
  v_max3_u32 v8, v20, v21, v22
  v_max3_u32 v8, v8, v23, v24
  v_max3_u32 v8, v8, v25, v26
  v_max3_u32 v8, v8, v27, v28
  v_max3_u32 v8, v8, v29, v30
  v_max3_u32 v8, v8, v31, v32
  v_max3_u32 v8, v8, v33, v34
  v_max_u32 v8, v8, v35
  v_max3_u32 v9, v36, v37, v38
  v_max3_u32 v9, v9, v39, v40
  v_max3_u32 v9, v9, v41, v42
  v_max3_u32 v9, v9, v43, v44
  v_max3_u32 v9, v9, v45, v46
  v_max3_u32 v9, v9, v47, v48
  v_max3_u32 v9, v9, v49, v50
  v_max_u32 v9, v9, v51
  v_max_u32 v8, v8, v9
  v_cmp_eq_u32 vcc, -1, v8
  s_cbranch_vccz L_gxXP_31
  s_mov_b64 exec, vcc
  s_sub_u32 s14, s14, 1
  s_cmp_eq_u32 s14, 0
  s_cbranch_scc0 L_gXP_30
L_gxXP_31:
  s_mov_b64 exec, -1
  v_pk_add_f32 v[20:21], v[20:21], v[24:25]
  v_pk_add_f32 v[22:23], v[22:23], v[26:27]
  v_pk_add_f32 v[28:29], v[28:29], v[32:33]
  v_pk_add_f32 v[30:31], v[30:31], v[34:35]
  v_pk_add_f32 v[36:37], v[36:37], v[40:41]
  v_pk_add_f32 v[38:39], v[38:39], v[42:43]
  v_pk_add_f32 v[44:45], v[44:45], v[48:49]
  v_pk_add_f32 v[46:47], v[46:47], v[50:51]
  v_pk_add_f32 v[20:21], v[20:21], v[28:29]
  v_pk_add_f32 v[22:23], v[22:23], v[30:31]
  v_pk_add_f32 v[36:37], v[36:37], v[44:45]
  v_pk_add_f32 v[38:39], v[38:39], v[46:47]
  v_pk_add_f32 v[20:21], v[20:21], v[36:37]
  v_pk_add_f32 v[22:23], v[22:23], v[38:39]
  s_nop 1
  v_permlane32_swap_b32 v20, v22
  v_permlane32_swap_b32 v21, v23
  v_add_f32 v20, v20, v22
  v_add_f32 v21, v21, v23
  s_nop 1
  v_permlane16_swap_b32 v20, v21
  v_add_f32 v20, v20, v21
  s_nop 1
  v_add_f32_dpp v20, v20, v20 row_ror:8 row_mask:0xf bank_mask:0xf
  ds_write_b32 v159, v20 offset:7168
  s_waitcnt lgkmcnt(0)
  s_barrier
  ds_read_b32 v20, v17 offset:7168
  ds_read_b32 v21, v17 offset:7296
  ds_read_b32 v22, v17 offset:7424
  ds_read_b32 v23, v17 offset:7552
  s_waitcnt lgkmcnt(0)
  v_add_f32 v20, v20, v21
  v_add_f32 v22, v22, v23
  v_add_f32 v20, v20, v22
  v_cvt_pk_bf16_f32 v20, v20, v20
  v_and_b32 v20, 0xffff0000, v20
  v_mul_f32 v20, v20, v148
  v_cvt_pk_bf16_f32 v20, v20, v20
  v_and_b32 v20, 0xffff0000, v20
  v_add_f32 v150, v150, v20
  v_cvt_pk_bf16_f32 v150, v150, v150
  v_and_b32 v150, 0xffff0000, v150
  v_min_u32 v9, 0xfffffffe, v150
  s_cmp_lg_u32 s3, 0
  s_cbranch_scc1 L_x1_32
  buffer_store_dword v9, v17, s[48:51], s32 offen sc1
L_x1_32:
  s_mov_b32 s14, 65536
L_gYP_33:
  buffer_load_dwordx4 v[20:23], v5, s[48:51], s12 offen offset:0 sc1
  buffer_load_dwordx4 v[24:27], v5, s[48:51], s12 offen offset:1024 sc1
  buffer_load_dwordx4 v[28:31], v5, s[48:51], s12 offen offset:2048 sc1
  buffer_load_dwordx4 v[32:35], v5, s[48:51], s12 offen offset:3072 sc1
  buffer_load_dwordx4 v[36:39], v5, s[48:51], s35 offen offset:0 sc1
  buffer_load_dwordx4 v[40:43], v5, s[48:51], s35 offen offset:1024 sc1
  buffer_load_dwordx4 v[44:47], v5, s[48:51], s35 offen offset:2048 sc1
  s_waitcnt vmcnt(0)
  v_max3_u32 v8, v20, v21, v22
  v_max3_u32 v8, v8, v23, v24
  v_max3_u32 v8, v8, v25, v26
  v_max3_u32 v8, v8, v27, v28
  v_max3_u32 v8, v8, v29, v30
  v_max3_u32 v8, v8, v31, v32
  v_max_u32 v8, v8, v33
  v_max3_u32 v9, v34, v35, v36
  v_max3_u32 v9, v9, v37, v38
  v_max3_u32 v9, v9, v39, v40
  v_max3_u32 v9, v9, v41, v42
  v_max3_u32 v9, v9, v43, v44
  v_max3_u32 v9, v9, v45, v46
  v_max_u32 v9, v9, v47
  v_max_u32 v8, v8, v9
  v_cmp_eq_u32 vcc, -1, v8
  s_cbranch_vccz L_gxYP_34
  s_mov_b64 exec, vcc
  s_sub_u32 s14, s14, 1
  s_cmp_eq_u32 s14, 0
  s_cbranch_scc0 L_gYP_33
L_gxYP_34:
  s_mov_b64 exec, -1
  v_pk_add_f32 v[20:21], v[20:21], v[24:25]
  v_pk_add_f32 v[22:23], v[22:23], v[26:27]
  v_pk_add_f32 v[28:29], v[28:29], v[32:33]
  v_pk_add_f32 v[30:31], v[30:31], v[34:35]
  v_pk_add_f32 v[36:37], v[36:37], v[40:41]
  v_pk_add_f32 v[38:39], v[38:39], v[42:43]
  v_pk_add_f32 v[20:21], v[20:21], v[28:29]
  v_pk_add_f32 v[22:23], v[22:23], v[30:31]
  v_pk_add_f32 v[36:37], v[36:37], v[44:45]
  v_pk_add_f32 v[38:39], v[38:39], v[46:47]
  v_pk_add_f32 v[20:21], v[20:21], v[36:37]
  v_pk_add_f32 v[22:23], v[22:23], v[38:39]
  s_nop 1
  v_permlane32_swap_b32 v20, v22
  v_permlane32_swap_b32 v21, v23
  v_add_f32 v20, v20, v22
  v_add_f32 v21, v21, v23
  s_nop 1
  v_permlane16_swap_b32 v20, v21
  v_add_f32 v20, v20, v21
  s_nop 1
  v_add_f32_dpp v20, v20, v20 row_ror:8 row_mask:0xf bank_mask:0xf
  ds_write_b32 v159, v20 offset:7680
  s_waitcnt lgkmcnt(0)
  s_barrier
  ds_read_b32 v20, v17 offset:7680
  ds_read_b32 v21, v17 offset:7808
  ds_read_b32 v22, v17 offset:7936
  ds_read_b32 v23, v17 offset:8064
  s_waitcnt lgkmcnt(0)
  v_add_f32 v20, v20, v21
  v_add_f32 v22, v22, v23
  v_add_f32 v20, v20, v22
  v_cvt_pk_bf16_f32 v20, v20, v20
  v_and_b32 v20, 0xffff0000, v20
  v_add_f32 v20, v20, v151
  v_cvt_pk_bf16_f32 v20, v20, v20
  v_and_b32 v20, 0xffff0000, v20
  v_mul_f32 v20, v20, v149
  v_cvt_pk_bf16_f32 v20, v20, v20
  v_and_b32 v20, 0xffff0000, v20
  v_add_f32 v20, v20, v150
  v_cvt_pk_bf16_f32 v20, v20, v20
  s_cmp_lg_u32 s3, 0
  s_cbranch_scc1 L_end
  buffer_store_short v20, v162, s[92:95], s33 offen sc1
  s_endpgm
L_t_worker:
  s_barrier
  s_cmp_eq_u32 s36, 1
  s_cbranch_scc1 L_w1have
  s_mov_b32 s4, s99
  buffer_load_dwordx4 v[116:119], v19, s[76:79], s4 offen nt
  s_add_u32 s4, s4, 7168
  buffer_load_dwordx4 v[120:123], v19, s[76:79], s4 offen nt
  s_add_u32 s4, s4, 7168
  buffer_load_dwordx4 v[124:127], v19, s[76:79], s4 offen nt
  s_add_u32 s4, s4, 7168
  buffer_load_dwordx4 v[128:131], v19, s[76:79], s4 offen nt
  s_add_u32 s4, s4, 7168
  buffer_load_dwordx4 v[132:135], v19, s[76:79], s4 offen nt
  s_add_u32 s4, s4, 7168
  buffer_load_dwordx4 v[136:139], v19, s[76:79], s4 offen nt
  s_add_u32 s4, s4, 7168
  buffer_load_dwordx4 v[140:143], v19, s[76:79], s4 offen nt
  s_add_u32 s4, s4, 7168
  buffer_load_dwordx4 v[144:147], v19, s[76:79], s4 offen nt
L_w1have:
  s_sub_u32 s16, s42, 4096
  s_sub_u32 s17, s43, 4096
  s_sub_u32 s18, s44, 4096
  s_sub_u32 s19, s45, 4096
  s_mov_b32 s14, 65536
  buffer_load_dword v148, v165, s[48:51], s16 offen sc1
  buffer_load_dword v149, v165, s[48:51], s17 offen sc1
  buffer_load_dword v150, v165, s[48:51], s18 offen sc1
  buffer_load_dword v151, v165, s[48:51], s19 offen sc1
  s_waitcnt vmcnt(4)
  v_lshlrev_b32 v20, 16, v116
  v_and_b32 v21, 0xffff0000, v116
  v_lshlrev_b32 v22, 16, v117
  v_and_b32 v23, 0xffff0000, v117
  v_lshlrev_b32 v24, 16, v118
  v_and_b32 v25, 0xffff0000, v118
  v_lshlrev_b32 v26, 16, v119
  v_and_b32 v27, 0xffff0000, v119
  v_lshlrev_b32 v28, 16, v120
  v_and_b32 v29, 0xffff0000, v120
  v_lshlrev_b32 v30, 16, v121
  v_and_b32 v31, 0xffff0000, v121
  v_lshlrev_b32 v32, 16, v122
  v_and_b32 v33, 0xffff0000, v122
  v_lshlrev_b32 v34, 16, v123
  v_and_b32 v35, 0xffff0000, v123
  v_lshlrev_b32 v36, 16, v124
  v_and_b32 v37, 0xffff0000, v124
  v_lshlrev_b32 v38, 16, v125
  v_and_b32 v39, 0xffff0000, v125
  v_lshlrev_b32 v40, 16, v126
  v_and_b32 v41, 0xffff0000, v126
  v_lshlrev_b32 v42, 16, v127
  v_and_b32 v43, 0xffff0000, v127
  v_lshlrev_b32 v44, 16, v128
  v_and_b32 v45, 0xffff0000, v128
  v_lshlrev_b32 v46, 16, v129
  v_and_b32 v47, 0xffff0000, v129
  v_lshlrev_b32 v48, 16, v130
  v_and_b32 v49, 0xffff0000, v130
  v_lshlrev_b32 v50, 16, v131
  v_and_b32 v51, 0xffff0000, v131
  v_lshlrev_b32 v52, 16, v132
  v_and_b32 v53, 0xffff0000, v132
  v_lshlrev_b32 v54, 16, v133
  v_and_b32 v55, 0xffff0000, v133
  v_lshlrev_b32 v56, 16, v134
  v_and_b32 v57, 0xffff0000, v134
  v_lshlrev_b32 v58, 16, v135
  v_and_b32 v59, 0xffff0000, v135
  v_lshlrev_b32 v60, 16, v136
  v_and_b32 v61, 0xffff0000, v136
  v_lshlrev_b32 v62, 16, v137
  v_and_b32 v63, 0xffff0000, v137
  v_lshlrev_b32 v64, 16, v138
  v_and_b32 v65, 0xffff0000, v138
  v_lshlrev_b32 v66, 16, v139
  v_and_b32 v67, 0xffff0000, v139
  v_lshlrev_b32 v68, 16, v140
  v_and_b32 v69, 0xffff0000, v140
  v_lshlrev_b32 v70, 16, v141
  v_and_b32 v71, 0xffff0000, v141
  v_lshlrev_b32 v72, 16, v142
  v_and_b32 v73, 0xffff0000, v142
  v_lshlrev_b32 v74, 16, v143
  v_and_b32 v75, 0xffff0000, v143
  v_lshlrev_b32 v76, 16, v144
  v_and_b32 v77, 0xffff0000, v144
  v_lshlrev_b32 v78, 16, v145
  v_and_b32 v79, 0xffff0000, v145
  v_lshlrev_b32 v80, 16, v146
  v_and_b32 v81, 0xffff0000, v146
  v_lshlrev_b32 v82, 16, v147
  v_and_b32 v83, 0xffff0000, v147
  s_lshl_b32 s4, s37, 15
  buffer_load_dwordx2 v[116:117], v18, s[80:83], s4 offen offset:0 nt
  buffer_load_dwordx2 v[118:119], v18, s[80:83], s4 offen offset:2048 nt
  s_add_u32 s4, s4, 4096
  buffer_load_dwordx2 v[120:121], v18, s[80:83], s4 offen offset:0 nt
  buffer_load_dwordx2 v[122:123], v18, s[80:83], s4 offen offset:2048 nt
  s_add_u32 s4, s4, 4096
  buffer_load_dwordx2 v[124:125], v18, s[80:83], s4 offen offset:0 nt
  buffer_load_dwordx2 v[126:127], v18, s[80:83], s4 offen offset:2048 nt
  s_add_u32 s4, s4, 4096
  buffer_load_dwordx2 v[128:129], v18, s[80:83], s4 offen offset:0 nt
  buffer_load_dwordx2 v[130:131], v18, s[80:83], s4 offen offset:2048 nt
  s_add_u32 s4, s4, 4096
  buffer_load_dwordx2 v[132:133], v18, s[80:83], s4 offen offset:0 nt
  buffer_load_dwordx2 v[134:135], v18, s[80:83], s4 offen offset:2048 nt
  s_add_u32 s4, s4, 4096
  buffer_load_dwordx2 v[136:137], v18, s[80:83], s4 offen offset:0 nt
  buffer_load_dwordx2 v[138:139], v18, s[80:83], s4 offen offset:2048 nt
  s_add_u32 s4, s4, 4096
  buffer_load_dwordx2 v[140:141], v18, s[80:83], s4 offen offset:0 nt
  buffer_load_dwordx2 v[142:143], v18, s[80:83], s4 offen offset:2048 nt
  s_add_u32 s4, s4, 4096
  buffer_load_dwordx2 v[144:145], v18, s[80:83], s4 offen offset:0 nt
  buffer_load_dwordx2 v[146:147], v18, s[80:83], s4 offen offset:2048 nt
  s_branch L_gmCS_37
L_gCS_35:
  buffer_load_dword v148, v165, s[48:51], s16 offen sc1
  buffer_load_dword v149, v165, s[48:51], s17 offen sc1
  buffer_load_dword v150, v165, s[48:51], s18 offen sc1
  buffer_load_dword v151, v165, s[48:51], s19 offen sc1
L_gmCS_37:
  s_waitcnt vmcnt(0)
  v_max3_u32 v8, v148, v149, v150
  v_max_u32 v8, v8, v151
  v_cmp_eq_u32 vcc, -1, v8
  s_cbranch_vccz L_gxCS_36
  s_mov_b64 exec, vcc
  s_sub_u32 s14, s14, 1
  s_cmp_eq_u32 s14, 0
  s_cbranch_scc0 L_gCS_35
L_gxCS_36:
  s_mov_b64 exec, -1
  s_mov_b32 s14, 65536
L_gX1_38:
  buffer_load_dword v152, v165, s[48:51], s42 offen sc1
  buffer_load_dword v153, v165, s[48:51], s43 offen sc1
  buffer_load_dword v154, v165, s[48:51], s44 offen sc1
  buffer_load_dword v155, v165, s[48:51], s45 offen sc1
  s_waitcnt vmcnt(0)
  v_max3_u32 v8, v152, v153, v154
  v_max_u32 v8, v8, v155
  v_cmp_eq_u32 vcc, -1, v8
  s_cbranch_vccz L_gxX1_39
  s_mov_b64 exec, vcc
  s_sub_u32 s14, s14, 1
  s_cmp_eq_u32 s14, 0
  s_cbranch_scc0 L_gX1_38
L_gxX1_39:
  s_mov_b64 exec, -1
  v_add_f32 v10, v152, v153
  v_mul_f32 v11, v152, v152
  v_add_f32 v8, v154, v155
  v_fmac_f32 v11, v153, v153
  v_mul_f32 v9, v154, v154
  v_add_f32 v10, v10, v8
  v_fmac_f32 v9, v155, v155
  v_add_f32 v11, v11, v9
  s_nop 1
  v_permlane32_swap_b32 v10, v11
  v_add_f32 v10, v10, v11
  v_mov_b32 v11, v10
  s_nop 1
  v_permlane16_swap_b32 v10, v11
  v_add_f32 v10, v10, v11
  s_nop 1
  v_add_f32_dpp v10, v10, v10 row_ror:8 row_mask:0xf bank_mask:0xf
  s_nop 1
  v_add_f32_dpp v10, v10, v10 row_ror:4 row_mask:0xf bank_mask:0xf
  s_nop 1
  v_add_f32_dpp v10, v10, v10 row_ror:2 row_mask:0xf bank_mask:0xf
  s_nop 1
  v_add_f32_dpp v10, v10, v10 row_ror:1 row_mask:0xf bank_mask:0xf
  ds_write_b32 v161, v10 offset:8192
  s_waitcnt lgkmcnt(0)
  s_barrier
  ds_read_b32 v10, v164 offset:8192
  s_waitcnt lgkmcnt(0)
  v_add_f32_dpp v10, v10, v10 quad_perm:[1,0,3,2] row_mask:0xf bank_mask:0xf
  s_nop 1
  v_add_f32_dpp v10, v10, v10 quad_perm:[2,3,0,1] row_mask:0xf bank_mask:0xf
  s_nop 1
  v_mov_b32_dpp v8, v10 row_ror:4 row_mask:0xf bank_mask:0xf
  v_cndmask_b32 v11, v8, v10, s[40:41]
  v_cndmask_b32 v10, v10, v8, s[40:41]
  v_mul_f32 v10, 0x3a800000, v10
  v_mul_f32 v11, 0x3a800000, v11
  v_fma_f32 v11, -v10, v10, v11
  v_max_f32 v11, 0, v11
  v_cvt_pk_bf16_f32 v8, v10, v11
  v_lshlrev_b32 v10, 16, v8
  v_and_b32 v11, 0xffff0000, v8
  v_add_f32 v11, 0x3727c5ac, v11
  v_cvt_pk_bf16_f32 v11, v11, v11
  v_and_b32 v11, 0xffff0000, v11
  v_sqrt_f32 v11, v11
  s_nop 0
  v_cvt_pk_bf16_f32 v11, v11, v11
  v_and_b32 v11, 0xffff0000, v11
  v_rcp_f32 v11, v11
  v_sub_f32 v152, v152, v10
  v_sub_f32 v153, v153, v10
  v_sub_f32 v154, v154, v10
  v_sub_f32 v155, v155, v10
  v_cvt_pk_bf16_f32 v8, v152, v153
  v_lshlrev_b32 v152, 16, v8
  v_and_b32 v153, 0xffff0000, v8
  v_cvt_pk_bf16_f32 v9, v154, v155
  v_lshlrev_b32 v154, 16, v9
  v_and_b32 v155, 0xffff0000, v9
  v_mul_f32 v152, v152, v11
  v_mul_f32 v153, v153, v11
  v_mul_f32 v154, v154, v11
  v_mul_f32 v155, v155, v11
  v_cvt_pk_bf16_f32 v8, v152, v153
  v_lshlrev_b32 v152, 16, v8
  v_and_b32 v153, 0xffff0000, v8
  v_cvt_pk_bf16_f32 v9, v154, v155
  v_lshlrev_b32 v154, 16, v9
  v_and_b32 v155, 0xffff0000, v9
  v_lshlrev_b32 v8, 16, v148
  v_lshlrev_b32 v9, 16, v149
  v_lshlrev_b32 v10, 16, v150
  v_lshlrev_b32 v11, 16, v151
  v_mul_f32 v152, v152, v8
  v_mul_f32 v153, v153, v9
  v_mul_f32 v154, v154, v10
  v_mul_f32 v155, v155, v11
  v_cvt_pk_bf16_f32 v8, v152, v153
  v_lshlrev_b32 v152, 16, v8
  v_and_b32 v153, 0xffff0000, v8
  v_cvt_pk_bf16_f32 v9, v154, v155
  v_lshlrev_b32 v154, 16, v9
  v_and_b32 v155, 0xffff0000, v9
  v_and_b32 v8, 0xffff0000, v148
  v_and_b32 v9, 0xffff0000, v149
  v_and_b32 v10, 0xffff0000, v150
  v_and_b32 v11, 0xffff0000, v151
  v_add_f32 v152, v152, v8
  v_add_f32 v153, v153, v9
  v_add_f32 v154, v154, v10
  v_add_f32 v155, v155, v11
  v_cvt_pk_bf16_f32 v8, v152, v153
  v_lshlrev_b32 v152, 16, v8
  v_and_b32 v153, 0xffff0000, v8
  v_cvt_pk_bf16_f32 v9, v154, v155
  v_lshlrev_b32 v154, 16, v9
  v_and_b32 v155, 0xffff0000, v9
  v_add_f32 v10, v152, v153
  v_mul_f32 v11, v152, v152
  v_add_f32 v8, v154, v155
  v_fmac_f32 v11, v153, v153
  v_mul_f32 v9, v154, v154
  v_add_f32 v10, v10, v8
  v_fmac_f32 v9, v155, v155
  v_add_f32 v11, v11, v9
  s_nop 1
  v_permlane32_swap_b32 v10, v11
  v_add_f32 v10, v10, v11
  v_mov_b32 v11, v10
  s_nop 1
  v_permlane16_swap_b32 v10, v11
  v_add_f32 v10, v10, v11
  s_nop 1
  v_add_f32_dpp v10, v10, v10 row_ror:8 row_mask:0xf bank_mask:0xf
  s_nop 1
  v_add_f32_dpp v10, v10, v10 row_ror:4 row_mask:0xf bank_mask:0xf
  s_nop 1
  v_add_f32_dpp v10, v10, v10 row_ror:2 row_mask:0xf bank_mask:0xf
  s_nop 1
  v_add_f32_dpp v10, v10, v10 row_ror:1 row_mask:0xf bank_mask:0xf
  ds_write_b32 v161, v10 offset:8224
  s_waitcnt lgkmcnt(0)
  s_barrier
  ds_read_b32 v10, v164 offset:8224
  s_waitcnt lgkmcnt(0)
  v_add_f32_dpp v10, v10, v10 quad_perm:[1,0,3,2] row_mask:0xf bank_mask:0xf
  s_nop 1
  v_add_f32_dpp v10, v10, v10 quad_perm:[2,3,0,1] row_mask:0xf bank_mask:0xf
  s_nop 1
  v_mov_b32_dpp v8, v10 row_ror:4 row_mask:0xf bank_mask:0xf
  v_cndmask_b32 v11, v8, v10, s[40:41]
  v_cndmask_b32 v10, v10, v8, s[40:41]
  v_mul_f32 v10, 0x3a800000, v10
  v_mul_f32 v11, 0x3a800000, v11
  v_fma_f32 v11, -v10, v10, v11
  v_max_f32 v11, 0, v11
  v_cvt_pk_bf16_f32 v8, v10, v11
  v_lshlrev_b32 v10, 16, v8
  v_and_b32 v11, 0xffff0000, v8
  v_add_f32 v11, 0x3727c5ac, v11
  v_cvt_pk_bf16_f32 v11, v11, v11
  v_and_b32 v11, 0xffff0000, v11
  v_sqrt_f32 v11, v11
  s_nop 0
  v_cvt_pk_bf16_f32 v11, v11, v11
  v_and_b32 v11, 0xffff0000, v11
  v_rcp_f32 v11, v11
  v_sub_f32 v152, v152, v10
  v_sub_f32 v153, v153, v10
  v_sub_f32 v154, v154, v10
  v_sub_f32 v155, v155, v10
  v_cvt_pk_bf16_f32 v8, v152, v153
  v_lshlrev_b32 v152, 16, v8
  v_and_b32 v153, 0xffff0000, v8
  v_cvt_pk_bf16_f32 v9, v154, v155
  v_lshlrev_b32 v154, 16, v9
  v_and_b32 v155, 0xffff0000, v9
  v_mul_f32 v152, v152, v11
  v_mul_f32 v153, v153, v11
  v_mul_f32 v154, v154, v11
  v_mul_f32 v155, v155, v11
  v_cvt_pk_bf16_f32 v8, v152, v153
  v_lshlrev_b32 v152, 16, v8
  v_and_b32 v153, 0xffff0000, v8
  v_cvt_pk_bf16_f32 v9, v154, v155
  v_lshlrev_b32 v154, 16, v9
  v_and_b32 v155, 0xffff0000, v9
  ds_write_b32 v165, v152 offset:2304
  s_waitcnt lgkmcnt(0)
  ds_read_b128 v[8:11], v166 offset:2304
  ds_read_b128 v[12:15], v166 offset:2320
  s_waitcnt lgkmcnt(1)
  v_pk_mul_f32 v[20:21], v[20:21], v[8:9] op_sel_hi:[1,0]
  v_pk_mul_f32 v[22:23], v[22:23], v[8:9] op_sel_hi:[1,0]
  v_pk_mul_f32 v[24:25], v[24:25], v[8:9] op_sel_hi:[1,0]
  v_pk_mul_f32 v[26:27], v[26:27], v[8:9] op_sel_hi:[1,0]
  v_pk_fma_f32 v[20:21], v[28:29], v[8:9], v[20:21] op_sel:[0,1,0] op_sel_hi:[1,1,1]
  v_pk_fma_f32 v[22:23], v[30:31], v[8:9], v[22:23] op_sel:[0,1,0] op_sel_hi:[1,1,1]
  v_pk_fma_f32 v[24:25], v[32:33], v[8:9], v[24:25] op_sel:[0,1,0] op_sel_hi:[1,1,1]
  v_pk_fma_f32 v[26:27], v[34:35], v[8:9], v[26:27] op_sel:[0,1,0] op_sel_hi:[1,1,1]
  v_pk_fma_f32 v[20:21], v[36:37], v[10:11], v[20:21] op_sel_hi:[1,0,1]
  v_pk_fma_f32 v[22:23], v[38:39], v[10:11], v[22:23] op_sel_hi:[1,0,1]
  v_pk_fma_f32 v[24:25], v[40:41], v[10:11], v[24:25] op_sel_hi:[1,0,1]
  v_pk_fma_f32 v[26:27], v[42:43], v[10:11], v[26:27] op_sel_hi:[1,0,1]
  v_pk_fma_f32 v[20:21], v[44:45], v[10:11], v[20:21] op_sel:[0,1,0] op_sel_hi:[1,1,1]
  v_pk_fma_f32 v[22:23], v[46:47], v[10:11], v[22:23] op_sel:[0,1,0] op_sel_hi:[1,1,1]
  v_pk_fma_f32 v[24:25], v[48:49], v[10:11], v[24:25] op_sel:[0,1,0] op_sel_hi:[1,1,1]
  v_pk_fma_f32 v[26:27], v[50:51], v[10:11], v[26:27] op_sel:[0,1,0] op_sel_hi:[1,1,1]
  s_waitcnt lgkmcnt(0)
  v_pk_fma_f32 v[20:21], v[52:53], v[12:13], v[20:21] op_sel_hi:[1,0,1]
  v_pk_fma_f32 v[22:23], v[54:55], v[12:13], v[22:23] op_sel_hi:[1,0,1]
  v_pk_fma_f32 v[24:25], v[56:57], v[12:13], v[24:25] op_sel_hi:[1,0,1]
  v_pk_fma_f32 v[26:27], v[58:59], v[12:13], v[26:27] op_sel_hi:[1,0,1]
  v_pk_fma_f32 v[20:21], v[60:61], v[12:13], v[20:21] op_sel:[0,1,0] op_sel_hi:[1,1,1]
  v_pk_fma_f32 v[22:23], v[62:63], v[12:13], v[22:23] op_sel:[0,1,0] op_sel_hi:[1,1,1]
  v_pk_fma_f32 v[24:25], v[64:65], v[12:13], v[24:25] op_sel:[0,1,0] op_sel_hi:[1,1,1]
  v_pk_fma_f32 v[26:27], v[66:67], v[12:13], v[26:27] op_sel:[0,1,0] op_sel_hi:[1,1,1]
  v_pk_fma_f32 v[20:21], v[68:69], v[14:15], v[20:21] op_sel_hi:[1,0,1]
  v_pk_fma_f32 v[22:23], v[70:71], v[14:15], v[22:23] op_sel_hi:[1,0,1]
  v_pk_fma_f32 v[24:25], v[72:73], v[14:15], v[24:25] op_sel_hi:[1,0,1]
  v_pk_fma_f32 v[26:27], v[74:75], v[14:15], v[26:27] op_sel_hi:[1,0,1]
  v_pk_fma_f32 v[20:21], v[76:77], v[14:15], v[20:21] op_sel:[0,1,0] op_sel_hi:[1,1,1]
  v_pk_fma_f32 v[22:23], v[78:79], v[14:15], v[22:23] op_sel:[0,1,0] op_sel_hi:[1,1,1]
  v_pk_fma_f32 v[24:25], v[80:81], v[14:15], v[24:25] op_sel:[0,1,0] op_sel_hi:[1,1,1]
  v_pk_fma_f32 v[26:27], v[82:83], v[14:15], v[26:27] op_sel:[0,1,0] op_sel_hi:[1,1,1]
  s_nop 0
  v_permlane32_swap_b32 v20, v24
  v_permlane32_swap_b32 v21, v25
  v_permlane32_swap_b32 v22, v26
  v_permlane32_swap_b32 v23, v27
  v_add_f32 v20, v20, v24
  v_add_f32 v21, v21, v25
  v_add_f32 v22, v22, v26
  v_add_f32 v23, v23, v27
  s_nop 0
  v_permlane16_swap_b32 v20, v22
  v_permlane16_swap_b32 v21, v23
  v_add_f32 v20, v20, v22
  v_add_f32 v21, v21, v23
  s_nop 0
  v_add_f32_dpp v20, v20, v20 row_ror:8 row_mask:0xf bank_mask:0xf
  v_add_f32_dpp v21, v21, v21 row_ror:8 row_mask:0xf bank_mask:0xf
  ds_write_b64 v160, v[20:21] offset:3328
  s_waitcnt lgkmcnt(0)
  s_barrier
  s_cmp_lg_u32 s3, 0
  s_cbranch_scc1 L_up_40
  ds_read_b32 v20, v4 offset:3328
  ds_read_b32 v21, v4 offset:3584
  ds_read_b32 v22, v4 offset:3840
  ds_read_b32 v23, v4 offset:4096
  s_waitcnt lgkmcnt(0)
  v_add_f32 v20, v20, v21
  v_add_f32 v22, v22, v23
  v_add_f32 v20, v20, v22
  v_min_u32 v20, 0xfffffffe, v20
  buffer_store_dword v20, v4, s[48:51], s46 offen sc1
L_up_40:
  s_mov_b32 s14, 65536
  buffer_load_dword v24, v167, s[48:51], s47 offen sc1
  s_waitcnt vmcnt(1)
  v_lshlrev_b32 v84, 16, v116
  v_and_b32 v85, 0xffff0000, v116
  v_lshlrev_b32 v86, 16, v117
  v_and_b32 v87, 0xffff0000, v117
  v_lshlrev_b32 v88, 16, v118
  v_and_b32 v89, 0xffff0000, v118
  v_lshlrev_b32 v90, 16, v119
  v_and_b32 v91, 0xffff0000, v119
  v_lshlrev_b32 v92, 16, v120
  v_and_b32 v93, 0xffff0000, v120
  v_lshlrev_b32 v94, 16, v121
  v_and_b32 v95, 0xffff0000, v121
  v_lshlrev_b32 v96, 16, v122
  v_and_b32 v97, 0xffff0000, v122
  v_lshlrev_b32 v98, 16, v123
  v_and_b32 v99, 0xffff0000, v123
  v_lshlrev_b32 v100, 16, v124
  v_and_b32 v101, 0xffff0000, v124
  v_lshlrev_b32 v102, 16, v125
  v_and_b32 v103, 0xffff0000, v125
  v_lshlrev_b32 v104, 16, v126
  v_and_b32 v105, 0xffff0000, v126
  v_lshlrev_b32 v106, 16, v127
  v_and_b32 v107, 0xffff0000, v127
  v_lshlrev_b32 v108, 16, v128
  v_and_b32 v109, 0xffff0000, v128
  v_lshlrev_b32 v110, 16, v129
  v_and_b32 v111, 0xffff0000, v129
  v_lshlrev_b32 v112, 16, v130
  v_and_b32 v113, 0xffff0000, v130
  v_lshlrev_b32 v114, 16, v131
  v_and_b32 v115, 0xffff0000, v131
  v_lshlrev_b32 v116, 16, v132
  v_and_b32 v117, 0xffff0000, v132
  v_lshlrev_b32 v118, 16, v133
  v_and_b32 v119, 0xffff0000, v133
  v_lshlrev_b32 v120, 16, v134
  v_and_b32 v121, 0xffff0000, v134
  v_lshlrev_b32 v122, 16, v135
  v_and_b32 v123, 0xffff0000, v135
  v_lshlrev_b32 v124, 16, v136
  v_and_b32 v125, 0xffff0000, v136
  v_lshlrev_b32 v126, 16, v137
  v_and_b32 v127, 0xffff0000, v137
  v_lshlrev_b32 v128, 16, v138
  v_and_b32 v129, 0xffff0000, v138
  v_lshlrev_b32 v130, 16, v139
  v_and_b32 v131, 0xffff0000, v139
  v_lshlrev_b32 v132, 16, v140
  v_and_b32 v133, 0xffff0000, v140
  v_lshlrev_b32 v134, 16, v141
  v_and_b32 v135, 0xffff0000, v141
  v_lshlrev_b32 v136, 16, v142
  v_and_b32 v137, 0xffff0000, v142
  v_lshlrev_b32 v138, 16, v143
  v_and_b32 v139, 0xffff0000, v143
  v_lshlrev_b32 v140, 16, v144
  v_and_b32 v141, 0xffff0000, v144
  v_lshlrev_b32 v142, 16, v145
  v_and_b32 v143, 0xffff0000, v145
  v_lshlrev_b32 v144, 16, v146
  v_and_b32 v145, 0xffff0000, v146
  v_lshlrev_b32 v146, 16, v147
  v_and_b32 v147, 0xffff0000, v147
  s_nop 1
  s_branch L_gmUP_43
L_gUP_41:
  buffer_load_dword v24, v167, s[48:51], s47 offen sc1
L_gmUP_43:
  s_waitcnt vmcnt(0)
  v_cmp_eq_u32 vcc, -1, v24
  s_cbranch_vccz L_gxUP_42
  s_mov_b64 exec, vcc
  s_sub_u32 s14, s14, 1
  s_cmp_eq_u32 s14, 0
  s_cbranch_scc0 L_gUP_41
L_gxUP_42:
  s_mov_b64 exec, -1
  v_mov_b32 v20, v24
  s_nop 1
  v_permlane16_swap_b32 v20, v24
  v_add_f32 v20, v20, v24
  v_mov_b32 v24, v20
  s_nop 1
  v_permlane32_swap_b32 v20, v24
  v_add_f32 v20, v20, v24
  v_cvt_pk_bf16_f32 v20, v20, v20
  v_and_b32 v20, 0xffff0000, v20
  v_add_f32 v20, v20, v156
  v_cvt_pk_bf16_f32 v20, v20, v20
  v_and_b32 v20, 0xffff0000, v20
  v_mul_f32 v21, v20, v20
  v_mov_b32 v22, 0xc0135761
  v_fmac_f32 v22, 0xbdd2d3e8, v21
  v_mul_f32 v22, v22, v20
  v_exp_f32 v22, v22
  s_nop 0
  v_add_f32 v22, 1.0, v22
  v_rcp_f32 v22, v22
  s_nop 0
  v_mul_f32 v20, v20, v22
  v_cvt_pk_bf16_f32 v20, v20, v20
  v_and_b32 v20, 0xffff0000, v20
  s_nop 0
  v_readlane_b32 s16, v20, 0
  v_readlane_b32 s17, v20, 1
  v_readlane_b32 s18, v20, 2
  v_readlane_b32 s19, v20, 3
  v_readlane_b32 s20, v20, 4
  v_readlane_b32 s21, v20, 5
  v_readlane_b32 s22, v20, 6
  v_readlane_b32 s23, v20, 7
  v_readlane_b32 s24, v20, 8
  v_readlane_b32 s25, v20, 9
  v_readlane_b32 s26, v20, 10
  v_readlane_b32 s27, v20, 11
  v_readlane_b32 s28, v20, 12
  v_readlane_b32 s29, v20, 13
  v_readlane_b32 s30, v20, 14
  v_readlane_b32 s31, v20, 15
  v_pk_mul_f32 v[152:153], v[84:85], s[16:17] op_sel_hi:[1,0]
  v_pk_mul_f32 v[154:155], v[86:87], s[16:17] op_sel_hi:[1,0]
  v_pk_mul_f32 v[8:9], v[88:89], s[16:17] op_sel:[0,1] op_sel_hi:[1,1]
  v_pk_mul_f32 v[10:11], v[90:91], s[16:17] op_sel:[0,1] op_sel_hi:[1,1]
  v_pk_fma_f32 v[152:153], v[92:93], s[18:19], v[152:153] op_sel_hi:[1,0,1]
  v_pk_fma_f32 v[154:155], v[94:95], s[18:19], v[154:155] op_sel_hi:[1,0,1]
  v_pk_fma_f32 v[8:9], v[96:97], s[18:19], v[8:9] op_sel:[0,1,0] op_sel_hi:[1,1,1]
  v_pk_fma_f32 v[10:11], v[98:99], s[18:19], v[10:11] op_sel:[0,1,0] op_sel_hi:[1,1,1]
  v_pk_fma_f32 v[152:153], v[100:101], s[20:21], v[152:153] op_sel_hi:[1,0,1]
  v_pk_fma_f32 v[154:155], v[102:103], s[20:21], v[154:155] op_sel_hi:[1,0,1]
  v_pk_fma_f32 v[8:9], v[104:105], s[20:21], v[8:9] op_sel:[0,1,0] op_sel_hi:[1,1,1]
  v_pk_fma_f32 v[10:11], v[106:107], s[20:21], v[10:11] op_sel:[0,1,0] op_sel_hi:[1,1,1]
  v_pk_fma_f32 v[152:153], v[108:109], s[22:23], v[152:153] op_sel_hi:[1,0,1]
  v_pk_fma_f32 v[154:155], v[110:111], s[22:23], v[154:155] op_sel_hi:[1,0,1]
  v_pk_fma_f32 v[8:9], v[112:113], s[22:23], v[8:9] op_sel:[0,1,0] op_sel_hi:[1,1,1]
  v_pk_fma_f32 v[10:11], v[114:115], s[22:23], v[10:11] op_sel:[0,1,0] op_sel_hi:[1,1,1]
  v_pk_fma_f32 v[152:153], v[116:117], s[24:25], v[152:153] op_sel_hi:[1,0,1]
  v_pk_fma_f32 v[154:155], v[118:119], s[24:25], v[154:155] op_sel_hi:[1,0,1]
  v_pk_fma_f32 v[8:9], v[120:121], s[24:25], v[8:9] op_sel:[0,1,0] op_sel_hi:[1,1,1]
  v_pk_fma_f32 v[10:11], v[122:123], s[24:25], v[10:11] op_sel:[0,1,0] op_sel_hi:[1,1,1]
  v_pk_fma_f32 v[152:153], v[124:125], s[26:27], v[152:153] op_sel_hi:[1,0,1]
  v_pk_fma_f32 v[154:155], v[126:127], s[26:27], v[154:155] op_sel_hi:[1,0,1]
  v_pk_fma_f32 v[8:9], v[128:129], s[26:27], v[8:9] op_sel:[0,1,0] op_sel_hi:[1,1,1]
  v_pk_fma_f32 v[10:11], v[130:131], s[26:27], v[10:11] op_sel:[0,1,0] op_sel_hi:[1,1,1]
  v_pk_fma_f32 v[152:153], v[132:133], s[28:29], v[152:153] op_sel_hi:[1,0,1]
  v_pk_fma_f32 v[154:155], v[134:135], s[28:29], v[154:155] op_sel_hi:[1,0,1]
  v_pk_fma_f32 v[8:9], v[136:137], s[28:29], v[8:9] op_sel:[0,1,0] op_sel_hi:[1,1,1]
  v_pk_fma_f32 v[10:11], v[138:139], s[28:29], v[10:11] op_sel:[0,1,0] op_sel_hi:[1,1,1]
  v_pk_fma_f32 v[152:153], v[140:141], s[30:31], v[152:153] op_sel_hi:[1,0,1]
  v_pk_fma_f32 v[154:155], v[142:143], s[30:31], v[154:155] op_sel_hi:[1,0,1]
  v_pk_fma_f32 v[8:9], v[144:145], s[30:31], v[8:9] op_sel:[0,1,0] op_sel_hi:[1,1,1]
  v_pk_fma_f32 v[10:11], v[146:147], s[30:31], v[10:11] op_sel:[0,1,0] op_sel_hi:[1,1,1]
  v_pk_add_f32 v[152:153], v[152:153], v[8:9]
  v_pk_add_f32 v[154:155], v[154:155], v[10:11]
  v_min_u32 v152, 0xfffffffe, v152
  v_min_u32 v153, 0xfffffffe, v153
  v_min_u32 v154, 0xfffffffe, v154
  v_min_u32 v155, 0xfffffffe, v155
  buffer_store_dwordx4 v[152:155], v7, s[48:51], s9 offen sc1
  s_endpgm
L_stream:
  s_sub_u32 s4, s3, 4
  v_lshlrev_b32 v2, 4, v0
  v_and_b32 v3, 7, v0
  v_lshrrev_b32 v5, 4, v0
  v_and_b32 v4, 15, v0
  v_lshlrev_b32 v6, 2, v5
  v_xor_b32 v6, v6, v4
  v_lshlrev_b32 v6, 4, v6
  v_lshl_add_u32 v136, v5, 8, v6
  v_xor_b32 v137, 16, v136
  v_xor_b32 v138, 32, v136
  v_xor_b32 v139, 48, v136
  v_lshlrev_b32 v152, 8, v3
  v_lshl_add_u32 v152, v5, 4, v152
  s_lshl_b32 s5, s2, 18
  s_mul_i32 s6, s4, 32768
  s_add_u32 s5, s5, s6
  s_and_b32 s6, s2, 63
  s_lshl_b32 s6, s6, 3
  s_add_u32 s6, s6, s4
  s_mul_i32 s6, s6, 8192
  s_lshr_b32 s5, s2, 6
  s_mul_i32 s5, s5, 16777216
  s_add_u32 s5, s5, s6
  s_mov_b32 s8, 0x05040100
  s_mov_b32 s9, 0x07060302
  s_mov_b32 s10, 0x3db504f3
  s_mov_b32 s11, 0x3fb8aa3b
  s_lshl_b32 s7, s4, 14
  s_add_u32 s7, s7, 9216
  v_and_b32 v6, 3, v0
  v_bfe_u32 v7, v0, 2, 2
  v_lshl_add_u32 v6, v6, 2, v7
  v_lshlrev_b32 v6, 8, v6
  v_xor_b32 v7, v5, v4
  v_lshl_add_u32 v7, v7, 4, v6
  v_add_u32 v7, s7, v7
  v_add_u32 v1, s7, v2
  s_waitcnt lgkmcnt(0)
  s_mov_b32 s48, s18
  s_mov_b32 s49, s19
  s_mov_b32 s50, 0x4000000
  s_mov_b32 s51, 0x20000
  s_mov_b32 s52, s20
  s_mov_b32 s53, s21
  s_mov_b32 s54, 0x4000000
  s_mov_b32 s55, 0x20000
  s_mov_b32 s56, s44
  s_mov_b32 s57, s45
  s_mov_b32 s58, 0x10000000
  s_mov_b32 s59, 0x20000
  s_mov_b32 s60, s42
  s_mov_b32 s61, s43
  s_mov_b32 s62, 0x100
  s_mov_b32 s63, 0x20000
  s_barrier
  s_setprio 2
  s_add_u32 s6, s5, 0
  buffer_load_dwordx4 v[8:11], v136, s[48:51], s6 offen offset:0 nt
  s_add_u32 s6, s5, 1024
  buffer_load_dwordx4 v[12:15], v137, s[48:51], s6 offen offset:0 nt
  s_add_u32 s6, s5, 2048
  buffer_load_dwordx4 v[16:19], v138, s[48:51], s6 offen offset:0 nt
  s_add_u32 s6, s5, 3072
  buffer_load_dwordx4 v[20:23], v139, s[48:51], s6 offen offset:0 nt
  s_cmp_lg_u32 s4, 0
  s_cbranch_scc1 L_s_clrdone
  v_lshlrev_b32 v117, 2, v0
  v_mov_b32 v118, -1
  s_and_b32 s12, s2, 63
  s_lshl_b32 s12, s12, 2
  s_lshr_b32 s13, s2, 6
  s_add_u32 s12, s12, s13
  s_lshl_b32 s12, s12, 8
  s_add_u32 s13, s12, 262144
  buffer_store_dword v118, v117, s[56:59], s13 offen sc1
  s_lshl_b32 s12, s2, 8
  s_add_u32 s12, s12, 393216
  buffer_store_dword v118, v117, s[56:59], s12 offen sc1
  v_and_b32 v119, 60, v117
  s_lshl_b32 s12, s2, 6
  s_add_u32 s12, s12, 327680
  buffer_store_dword v118, v119, s[56:59], s12 offen sc1
  s_cmp_lt_u32 s2, 224
  s_cbranch_scc1 L_s_clrdone
  v_and_b32 v119, 124, v117
  s_sub_u32 s12, s2, 224
  s_lshl_b32 s12, s12, 7
  s_add_u32 s13, s12, 344064
  s_add_u32 s12, s12, 348160
  buffer_store_dword v118, v119, s[56:59], s13 offen sc1
  buffer_store_dword v118, v119, s[56:59], s12 offen sc1
L_s_clrdone:
  s_cmp_ge_u32 s4, 4
  s_cbranch_scc1 L_s_noclr
  s_lshl_b32 s12, s4, 6
  v_add_u32 v112, s12, v0
  v_lshrrev_b32 v114, 5, v112
  v_bfe_u32 v115, v112, 2, 3
  v_and_b32 v116, 3, v112
  v_lshlrev_b32 v115, 3, v115
  v_lshl_add_u32 v115, v116, 1, v115
  v_lshrrev_b32 v116, 2, v114
  v_add_u32 v115, v115, v116
  v_lshlrev_b32 v115, 12, v115
  v_and_b32 v114, 3, v114
  v_lshl_add_u32 v113, v114, 4, v115
  v_lshrrev_b32 v115, 3, v112
  v_lshlrev_b32 v115, 15, v115
  v_and_b32 v114, 7, v112
  v_lshl_add_u32 v114, v114, 4, v115
  s_lshr_b32 s64, s2, 6
  s_lshl_b32 s64, s64, 18
  s_and_b32 s12, s2, 63
  s_lshl_b32 s12, s12, 6
  s_add_u32 s64, s64, s12
  s_add_u32 s64, s64, 1048576
  s_lshl_b32 s12, s2, 7
  s_add_u32 s65, s12, 2097152
  s_add_u32 s66, s12, 3145728
  v_mov_b32 v104, -1
  v_mov_b32 v105, -1
  v_mov_b32 v106, -1
  v_mov_b32 v107, -1
  buffer_store_dwordx4 v[104:107], v113, s[56:59], s64 offen sc1
  buffer_store_dwordx4 v[104:107], v114, s[56:59], s65 offen sc1
  buffer_store_dwordx4 v[104:107], v114, s[56:59], s66 offen sc1
L_s_noclr:
  s_add_u32 s6, s5, 4096
  buffer_load_dwordx4 v[24:27], v136, s[48:51], s6 offen offset:0 nt
  s_add_u32 s6, s5, 5120
  buffer_load_dwordx4 v[28:31], v137, s[48:51], s6 offen offset:0 nt
  s_add_u32 s6, s5, 6144
  buffer_load_dwordx4 v[32:35], v138, s[48:51], s6 offen offset:0 nt
  s_add_u32 s6, s5, 7168
  buffer_load_dwordx4 v[36:39], v139, s[48:51], s6 offen offset:0 nt
  s_add_u32 s6, s5, 4194304
  buffer_load_dwordx4 v[40:43], v136, s[48:51], s6 offen offset:0 nt
  s_add_u32 s6, s5, 4195328
  buffer_load_dwordx4 v[44:47], v137, s[48:51], s6 offen offset:0 nt
  s_add_u32 s6, s5, 4196352
  buffer_load_dwordx4 v[48:51], v138, s[48:51], s6 offen offset:0 nt
  s_add_u32 s6, s5, 4197376
  buffer_load_dwordx4 v[52:55], v139, s[48:51], s6 offen offset:0 nt
  s_cmp_ge_u32 s4, 4
  s_cbranch_scc1 L_s_noarr
  s_waitcnt vmcnt(8)
  v_mov_b32 v104, 0
  v_mov_b32 v105, 1
  s_mov_b64 exec, 1
  ds_add_rtn_u32 v105, v104, v105 offset:20
  s_waitcnt lgkmcnt(0)
  s_mov_b64 exec, -1
  v_readfirstlane_b32 s12, v105
  s_nop 0
  s_cmp_lg_u32 s12, 3
  s_cbranch_scc1 L_s_noarr
  s_setprio 3
  s_mov_b32 s14, 65536
  v_mov_b32 v4, 0
L_swsnap_44:
  ds_read_b32 v5, v4 offset:24
  s_waitcnt lgkmcnt(0)
  v_readfirstlane_b32 s15, v5
  s_nop 0
  s_cmp_ge_u32 s15, 4
  s_cbranch_scc1 L_swxsnap_45
  s_sleep 2
  s_sub_u32 s14, s14, 1
  s_cmp_eq_u32 s14, 0
  s_cbranch_scc0 L_swsnap_44
L_swxsnap_45:
  v_mov_b32 v104, 1
  v_mov_b32 v105, 0
  s_mov_b64 exec, 1
  buffer_atomic_add v104, v105, s[60:63], 0 offen offset:0 sc0
  s_waitcnt vmcnt(0)
  v_readfirstlane_b32 s12, v104
  s_nop 0
  s_cmp_lg_u32 s12, 255
  s_cbranch_scc1 L_sag2_46
  v_mov_b32 v104, 1
  buffer_store_dword v104, v105, s[60:63], 0 offen offset:128 sc1
L_sag2_46:
  s_mov_b64 exec, -1
  s_setprio 2
L_s_noarr:
  s_add_u32 s6, s5, 4198400
  buffer_load_dwordx4 v[56:59], v136, s[48:51], s6 offen offset:0 nt
  s_add_u32 s6, s5, 4199424
  buffer_load_dwordx4 v[60:63], v137, s[48:51], s6 offen offset:0 nt
  s_add_u32 s6, s5, 4200448
  buffer_load_dwordx4 v[64:67], v138, s[48:51], s6 offen offset:0 nt
  s_add_u32 s6, s5, 4201472
  buffer_load_dwordx4 v[68:71], v139, s[48:51], s6 offen offset:0 nt
  s_waitcnt vmcnt(15)
  s_add_u32 s6, s5, 8388608
  s_add_u32 m0, s7, 0
  s_nop 0
  buffer_load_dwordx4 v136, s[48:51], s6 offen offset:0 nt lds
  s_waitcnt vmcnt(15)
  s_add_u32 s6, s5, 8389632
  s_add_u32 m0, s7, 1024
  s_nop 0
  buffer_load_dwordx4 v137, s[48:51], s6 offen offset:0 nt lds
  s_waitcnt vmcnt(15)
  s_add_u32 s6, s5, 8390656
  s_add_u32 m0, s7, 2048
  s_nop 0
  buffer_load_dwordx4 v138, s[48:51], s6 offen offset:0 nt lds
  s_waitcnt vmcnt(15)
  s_add_u32 s6, s5, 8391680
  s_add_u32 m0, s7, 3072
  s_nop 0
  buffer_load_dwordx4 v139, s[48:51], s6 offen offset:0 nt lds
  s_waitcnt vmcnt(15)
  s_add_u32 s6, s5, 8392704
  s_add_u32 m0, s7, 4096
  s_nop 0
  buffer_load_dwordx4 v136, s[48:51], s6 offen offset:0 nt lds
  s_waitcnt vmcnt(15)
  s_add_u32 s6, s5, 8393728
  s_add_u32 m0, s7, 5120
  s_nop 0
  buffer_load_dwordx4 v137, s[48:51], s6 offen offset:0 nt lds
  s_waitcnt vmcnt(15)
  s_add_u32 s6, s5, 8394752
  s_add_u32 m0, s7, 6144
  s_nop 0
  buffer_load_dwordx4 v138, s[48:51], s6 offen offset:0 nt lds
  s_waitcnt vmcnt(15)
  s_add_u32 s6, s5, 8395776
  s_add_u32 m0, s7, 7168
  s_nop 0
  buffer_load_dwordx4 v139, s[48:51], s6 offen offset:0 nt lds
  s_waitcnt vmcnt(15)
  s_add_u32 s6, s5, 12582912
  s_add_u32 m0, s7, 8192
  s_nop 0
  buffer_load_dwordx4 v136, s[48:51], s6 offen offset:0 nt lds
  s_waitcnt vmcnt(15)
  s_add_u32 s6, s5, 12583936
  s_add_u32 m0, s7, 9216
  s_nop 0
  buffer_load_dwordx4 v137, s[48:51], s6 offen offset:0 nt lds
  s_waitcnt vmcnt(15)
  s_add_u32 s6, s5, 12584960
  s_add_u32 m0, s7, 10240
  s_nop 0
  buffer_load_dwordx4 v138, s[48:51], s6 offen offset:0 nt lds
  s_waitcnt vmcnt(15)
  s_add_u32 s6, s5, 12585984
  s_add_u32 m0, s7, 11264
  s_nop 0
  buffer_load_dwordx4 v139, s[48:51], s6 offen offset:0 nt lds
  s_waitcnt vmcnt(15)
  s_add_u32 s6, s5, 12587008
  s_add_u32 m0, s7, 12288
  s_nop 0
  buffer_load_dwordx4 v136, s[48:51], s6 offen offset:0 nt lds
  s_waitcnt vmcnt(15)
  s_add_u32 s6, s5, 12588032
  s_add_u32 m0, s7, 13312
  s_nop 0
  buffer_load_dwordx4 v137, s[48:51], s6 offen offset:0 nt lds
  s_waitcnt vmcnt(15)
  s_add_u32 s6, s5, 12589056
  s_add_u32 m0, s7, 14336
  s_nop 0
  buffer_load_dwordx4 v138, s[48:51], s6 offen offset:0 nt lds
  s_waitcnt vmcnt(15)
  s_add_u32 s6, s5, 12590080
  s_add_u32 m0, s7, 15360
  s_nop 0
  buffer_load_dwordx4 v139, s[48:51], s6 offen offset:0 nt lds
  s_setprio 1
  s_waitcnt vmcnt(15)
  s_add_u32 s6, s5, 0
  buffer_load_dwordx4 v[72:75], v2, s[52:55], s6 offen offset:0 nt
  s_waitcnt vmcnt(15)
  s_add_u32 s6, s5, 1024
  buffer_load_dwordx4 v[76:79], v2, s[52:55], s6 offen offset:0 nt
  s_waitcnt vmcnt(15)
  s_add_u32 s6, s5, 2048
  buffer_load_dwordx4 v[80:83], v2, s[52:55], s6 offen offset:0 nt
  s_waitcnt vmcnt(15)
  s_add_u32 s6, s5, 3072
  buffer_load_dwordx4 v[84:87], v2, s[52:55], s6 offen offset:0 nt
  s_waitcnt vmcnt(15)
  s_add_u32 s6, s5, 4096
  buffer_load_dwordx4 v[88:91], v2, s[52:55], s6 offen offset:0 nt
  s_waitcnt vmcnt(15)
  s_add_u32 s6, s5, 5120
  buffer_load_dwordx4 v[92:95], v2, s[52:55], s6 offen offset:0 nt
  s_waitcnt vmcnt(15)
  s_add_u32 s6, s5, 6144
  buffer_load_dwordx4 v[96:99], v2, s[52:55], s6 offen offset:0 nt
  s_waitcnt vmcnt(15)
  s_add_u32 s6, s5, 7168
  buffer_load_dwordx4 v[100:103], v2, s[52:55], s6 offen offset:0 nt
  s_mov_b32 s14, 65536
  v_mov_b32 v4, 0
L_swq_47:
  ds_read_b32 v5, v4 offset:12
  s_waitcnt lgkmcnt(0)
  v_readfirstlane_b32 s15, v5
  s_nop 0
  s_cmp_ge_u32 s15, 4
  s_cbranch_scc1 L_swxq_48
  s_sleep 2
  s_sub_u32 s14, s14, 1
  s_cmp_eq_u32 s14, 0
  s_cbranch_scc0 L_swq_47
L_swxq_48:
  ds_read_b128 v[136:139], v152 offset:256
  ds_read_b128 v[140:143], v152 offset:320
  ds_read_b128 v[144:147], v152 offset:384
  ds_read_b128 v[148:151], v152 offset:448
  s_waitcnt lgkmcnt(0)
  s_waitcnt vmcnt(20)
  ds_read_b128 v[152:155], v7 offset:0
  v_xor_b32 v4, 64, v7
  ds_read_b128 v[156:159], v4 offset:0
  v_xor_b32 v4, 128, v7
  ds_read_b128 v[160:163], v4 offset:0
  v_xor_b32 v4, 192, v7
  ds_read_b128 v[164:167], v4 offset:0
  s_waitcnt lgkmcnt(3)
  v_mfma_f32_16x16x32_bf16 v[120:123], v[152:155], v[136:139], 0
  s_waitcnt lgkmcnt(2)
  v_mfma_f32_16x16x32_bf16 v[120:123], v[156:159], v[140:143], v[120:123]
  s_waitcnt lgkmcnt(1)
  v_mfma_f32_16x16x32_bf16 v[120:123], v[160:163], v[144:147], v[120:123]
  s_waitcnt lgkmcnt(0)
  v_mfma_f32_16x16x32_bf16 v[120:123], v[164:167], v[148:151], v[120:123]
  s_waitcnt vmcnt(36)
  ds_write_b128 v1, v[8:11] offset:0
  ds_write_b128 v1, v[12:15] offset:1024
  ds_write_b128 v1, v[16:19] offset:2048
  ds_write_b128 v1, v[20:23] offset:3072
  ds_read_b128 v[152:155], v7 offset:0
  v_xor_b32 v4, 64, v7
  ds_read_b128 v[156:159], v4 offset:0
  v_xor_b32 v4, 128, v7
  ds_read_b128 v[160:163], v4 offset:0
  v_xor_b32 v4, 192, v7
  ds_read_b128 v[164:167], v4 offset:0
  s_waitcnt lgkmcnt(3)
  v_mfma_f32_16x16x32_bf16 v[104:107], v[152:155], v[136:139], 0
  s_waitcnt lgkmcnt(2)
  v_mfma_f32_16x16x32_bf16 v[104:107], v[156:159], v[140:143], v[104:107]
  s_waitcnt lgkmcnt(1)
  v_mfma_f32_16x16x32_bf16 v[104:107], v[160:163], v[144:147], v[104:107]
  s_waitcnt lgkmcnt(0)
  v_mfma_f32_16x16x32_bf16 v[104:107], v[164:167], v[148:151], v[104:107]
  s_waitcnt vmcnt(15)
  s_add_u32 s6, s5, 4194304
  buffer_load_dwordx4 v[8:11], v2, s[52:55], s6 offen offset:0 nt
  s_waitcnt vmcnt(15)
  s_add_u32 s6, s5, 4195328
  buffer_load_dwordx4 v[12:15], v2, s[52:55], s6 offen offset:0 nt
  s_waitcnt vmcnt(15)
  s_add_u32 s6, s5, 4196352
  buffer_load_dwordx4 v[16:19], v2, s[52:55], s6 offen offset:0 nt
  s_waitcnt vmcnt(15)
  s_add_u32 s6, s5, 4197376
  buffer_load_dwordx4 v[20:23], v2, s[52:55], s6 offen offset:0 nt
  s_waitcnt vmcnt(20)
  ds_read_b128 v[152:155], v7 offset:4096
  v_xor_b32 v4, 64, v7
  ds_read_b128 v[156:159], v4 offset:4096
  v_xor_b32 v4, 128, v7
  ds_read_b128 v[160:163], v4 offset:4096
  v_xor_b32 v4, 192, v7
  ds_read_b128 v[164:167], v4 offset:4096
  s_waitcnt lgkmcnt(3)
  v_mfma_f32_16x16x32_bf16 v[124:127], v[152:155], v[136:139], 0
  s_waitcnt lgkmcnt(2)
  v_mfma_f32_16x16x32_bf16 v[124:127], v[156:159], v[140:143], v[124:127]
  s_waitcnt lgkmcnt(1)
  v_mfma_f32_16x16x32_bf16 v[124:127], v[160:163], v[144:147], v[124:127]
  s_waitcnt lgkmcnt(0)
  v_mfma_f32_16x16x32_bf16 v[124:127], v[164:167], v[148:151], v[124:127]
  s_waitcnt vmcnt(36)
  ds_write_b128 v1, v[24:27] offset:4096
  ds_write_b128 v1, v[28:31] offset:5120
  ds_write_b128 v1, v[32:35] offset:6144
  ds_write_b128 v1, v[36:39] offset:7168
  ds_read_b128 v[152:155], v7 offset:4096
  v_xor_b32 v4, 64, v7
  ds_read_b128 v[156:159], v4 offset:4096
  v_xor_b32 v4, 128, v7
  ds_read_b128 v[160:163], v4 offset:4096
  v_xor_b32 v4, 192, v7
  ds_read_b128 v[164:167], v4 offset:4096
  s_waitcnt lgkmcnt(3)
  v_mfma_f32_16x16x32_bf16 v[108:111], v[152:155], v[136:139], 0
  s_waitcnt lgkmcnt(2)
  v_mfma_f32_16x16x32_bf16 v[108:111], v[156:159], v[140:143], v[108:111]
  s_waitcnt lgkmcnt(1)
  v_mfma_f32_16x16x32_bf16 v[108:111], v[160:163], v[144:147], v[108:111]
  s_waitcnt lgkmcnt(0)
  v_mfma_f32_16x16x32_bf16 v[108:111], v[164:167], v[148:151], v[108:111]
  s_waitcnt vmcnt(15)
  s_add_u32 s6, s5, 4198400
  buffer_load_dwordx4 v[24:27], v2, s[52:55], s6 offen offset:0 nt
  s_waitcnt vmcnt(15)
  s_add_u32 s6, s5, 4199424
  buffer_load_dwordx4 v[28:31], v2, s[52:55], s6 offen offset:0 nt
  s_waitcnt vmcnt(15)
  s_add_u32 s6, s5, 4200448
  buffer_load_dwordx4 v[32:35], v2, s[52:55], s6 offen offset:0 nt
  s_waitcnt vmcnt(15)
  s_add_u32 s6, s5, 4201472
  buffer_load_dwordx4 v[36:39], v2, s[52:55], s6 offen offset:0 nt
  s_waitcnt vmcnt(20)
  ds_read_b128 v[152:155], v7 offset:8192
  v_xor_b32 v4, 64, v7
  ds_read_b128 v[156:159], v4 offset:8192
  v_xor_b32 v4, 128, v7
  ds_read_b128 v[160:163], v4 offset:8192
  v_xor_b32 v4, 192, v7
  ds_read_b128 v[164:167], v4 offset:8192
  s_waitcnt lgkmcnt(3)
  v_mfma_f32_16x16x32_bf16 v[128:131], v[152:155], v[136:139], 0
  s_waitcnt lgkmcnt(2)
  v_mfma_f32_16x16x32_bf16 v[128:131], v[156:159], v[140:143], v[128:131]
  s_waitcnt lgkmcnt(1)
  v_mfma_f32_16x16x32_bf16 v[128:131], v[160:163], v[144:147], v[128:131]
  s_waitcnt lgkmcnt(0)
  v_mfma_f32_16x16x32_bf16 v[128:131], v[164:167], v[148:151], v[128:131]
  s_waitcnt vmcnt(36)
  ds_write_b128 v1, v[40:43] offset:8192
  ds_write_b128 v1, v[44:47] offset:9216
  ds_write_b128 v1, v[48:51] offset:10240
  ds_write_b128 v1, v[52:55] offset:11264
  ds_read_b128 v[152:155], v7 offset:8192
  v_xor_b32 v4, 64, v7
  ds_read_b128 v[156:159], v4 offset:8192
  v_xor_b32 v4, 128, v7
  ds_read_b128 v[160:163], v4 offset:8192
  v_xor_b32 v4, 192, v7
  ds_read_b128 v[164:167], v4 offset:8192
  s_waitcnt lgkmcnt(3)
  v_mfma_f32_16x16x32_bf16 v[112:115], v[152:155], v[136:139], 0
  s_waitcnt lgkmcnt(2)
  v_mfma_f32_16x16x32_bf16 v[112:115], v[156:159], v[140:143], v[112:115]
  s_waitcnt lgkmcnt(1)
  v_mfma_f32_16x16x32_bf16 v[112:115], v[160:163], v[144:147], v[112:115]
  s_waitcnt lgkmcnt(0)
  v_mfma_f32_16x16x32_bf16 v[112:115], v[164:167], v[148:151], v[112:115]
  s_waitcnt vmcnt(15)
  s_add_u32 s6, s5, 8388608
  buffer_load_dwordx4 v[40:43], v2, s[52:55], s6 offen offset:0 nt
  s_waitcnt vmcnt(15)
  s_add_u32 s6, s5, 8389632
  buffer_load_dwordx4 v[44:47], v2, s[52:55], s6 offen offset:0 nt
  s_waitcnt vmcnt(15)
  s_add_u32 s6, s5, 8390656
  buffer_load_dwordx4 v[48:51], v2, s[52:55], s6 offen offset:0 nt
  s_waitcnt vmcnt(15)
  s_add_u32 s6, s5, 8391680
  buffer_load_dwordx4 v[52:55], v2, s[52:55], s6 offen offset:0 nt
  s_waitcnt vmcnt(20)
  ds_read_b128 v[152:155], v7 offset:12288
  v_xor_b32 v4, 64, v7
  ds_read_b128 v[156:159], v4 offset:12288
  v_xor_b32 v4, 128, v7
  ds_read_b128 v[160:163], v4 offset:12288
  v_xor_b32 v4, 192, v7
  ds_read_b128 v[164:167], v4 offset:12288
  s_waitcnt lgkmcnt(3)
  v_mfma_f32_16x16x32_bf16 v[132:135], v[152:155], v[136:139], 0
  s_waitcnt lgkmcnt(2)
  v_mfma_f32_16x16x32_bf16 v[132:135], v[156:159], v[140:143], v[132:135]
  s_waitcnt lgkmcnt(1)
  v_mfma_f32_16x16x32_bf16 v[132:135], v[160:163], v[144:147], v[132:135]
  s_waitcnt lgkmcnt(0)
  v_mfma_f32_16x16x32_bf16 v[132:135], v[164:167], v[148:151], v[132:135]
  s_waitcnt vmcnt(36)
  ds_write_b128 v1, v[56:59] offset:12288
  ds_write_b128 v1, v[60:63] offset:13312
  ds_write_b128 v1, v[64:67] offset:14336
  ds_write_b128 v1, v[68:71] offset:15360
  ds_read_b128 v[152:155], v7 offset:12288
  v_xor_b32 v4, 64, v7
  ds_read_b128 v[156:159], v4 offset:12288
  v_xor_b32 v4, 128, v7
  ds_read_b128 v[160:163], v4 offset:12288
  v_xor_b32 v4, 192, v7
  ds_read_b128 v[164:167], v4 offset:12288
  s_waitcnt lgkmcnt(3)
  v_mfma_f32_16x16x32_bf16 v[116:119], v[152:155], v[136:139], 0
  s_waitcnt lgkmcnt(2)
  v_mfma_f32_16x16x32_bf16 v[116:119], v[156:159], v[140:143], v[116:119]
  s_waitcnt lgkmcnt(1)
  v_mfma_f32_16x16x32_bf16 v[116:119], v[160:163], v[144:147], v[116:119]
  s_waitcnt lgkmcnt(0)
  v_mfma_f32_16x16x32_bf16 v[116:119], v[164:167], v[148:151], v[116:119]
  s_setprio 0
  s_waitcnt vmcnt(15)
  s_add_u32 s6, s5, 8392704
  buffer_load_dwordx4 v[56:59], v2, s[52:55], s6 offen offset:0 nt
  s_waitcnt vmcnt(15)
  s_add_u32 s6, s5, 8393728
  buffer_load_dwordx4 v[60:63], v2, s[52:55], s6 offen offset:0 nt
  s_waitcnt vmcnt(15)
  s_add_u32 s6, s5, 8394752
  buffer_load_dwordx4 v[64:67], v2, s[52:55], s6 offen offset:0 nt
  s_waitcnt vmcnt(15)
  s_add_u32 s6, s5, 8395776
  buffer_load_dwordx4 v[68:71], v2, s[52:55], s6 offen offset:0 nt
  v_cvt_pk_bf16_f32 v156, v104, v105
  v_lshlrev_b32 v104, 16, v156
  v_and_b32 v105, 0xffff0000, v156
  v_mul_f32 v104, s10, v104
  v_mul_f32 v105, s10, v105
  v_cvt_pk_bf16_f32 v156, v104, v105
  v_lshlrev_b32 v104, 16, v156
  v_and_b32 v105, 0xffff0000, v156
  v_cvt_pk_bf16_f32 v157, v106, v107
  v_lshlrev_b32 v106, 16, v157
  v_and_b32 v107, 0xffff0000, v157
  v_mul_f32 v106, s10, v106
  v_mul_f32 v107, s10, v107
  v_cvt_pk_bf16_f32 v157, v106, v107
  v_lshlrev_b32 v106, 16, v157
  v_and_b32 v107, 0xffff0000, v157
  v_cvt_pk_bf16_f32 v158, v108, v109
  v_lshlrev_b32 v108, 16, v158
  v_and_b32 v109, 0xffff0000, v158
  v_mul_f32 v108, s10, v108
  v_mul_f32 v109, s10, v109
  v_cvt_pk_bf16_f32 v158, v108, v109
  v_lshlrev_b32 v108, 16, v158
  v_and_b32 v109, 0xffff0000, v158
  v_cvt_pk_bf16_f32 v159, v110, v111
  v_lshlrev_b32 v110, 16, v159
  v_and_b32 v111, 0xffff0000, v159
  v_mul_f32 v110, s10, v110
  v_mul_f32 v111, s10, v111
  v_cvt_pk_bf16_f32 v159, v110, v111
  v_lshlrev_b32 v110, 16, v159
  v_and_b32 v111, 0xffff0000, v159
  v_cvt_pk_bf16_f32 v156, v112, v113
  v_lshlrev_b32 v112, 16, v156
  v_and_b32 v113, 0xffff0000, v156
  v_mul_f32 v112, s10, v112
  v_mul_f32 v113, s10, v113
  v_cvt_pk_bf16_f32 v156, v112, v113
  v_lshlrev_b32 v112, 16, v156
  v_and_b32 v113, 0xffff0000, v156
  v_cvt_pk_bf16_f32 v157, v114, v115
  v_lshlrev_b32 v114, 16, v157
  v_and_b32 v115, 0xffff0000, v157
  v_mul_f32 v114, s10, v114
  v_mul_f32 v115, s10, v115
  v_cvt_pk_bf16_f32 v157, v114, v115
  v_lshlrev_b32 v114, 16, v157
  v_and_b32 v115, 0xffff0000, v157
  v_cvt_pk_bf16_f32 v158, v116, v117
  v_lshlrev_b32 v116, 16, v158
  v_and_b32 v117, 0xffff0000, v158
  v_mul_f32 v116, s10, v116
  v_mul_f32 v117, s10, v117
  v_cvt_pk_bf16_f32 v158, v116, v117
  v_lshlrev_b32 v116, 16, v158
  v_and_b32 v117, 0xffff0000, v158
  v_cvt_pk_bf16_f32 v159, v118, v119
  v_lshlrev_b32 v118, 16, v159
  v_and_b32 v119, 0xffff0000, v159
  v_mul_f32 v118, s10, v118
  v_mul_f32 v119, s10, v119
  v_cvt_pk_bf16_f32 v159, v118, v119
  v_lshlrev_b32 v118, 16, v159
  v_and_b32 v119, 0xffff0000, v159
  v_cvt_pk_bf16_f32 v156, v120, v121
  v_lshlrev_b32 v120, 16, v156
  v_and_b32 v121, 0xffff0000, v156
  v_mul_f32 v120, s10, v120
  v_mul_f32 v121, s10, v121
  v_cvt_pk_bf16_f32 v156, v120, v121
  v_lshlrev_b32 v120, 16, v156
  v_and_b32 v121, 0xffff0000, v156
  v_cvt_pk_bf16_f32 v157, v122, v123
  v_lshlrev_b32 v122, 16, v157
  v_and_b32 v123, 0xffff0000, v157
  v_mul_f32 v122, s10, v122
  v_mul_f32 v123, s10, v123
  v_cvt_pk_bf16_f32 v157, v122, v123
  v_lshlrev_b32 v122, 16, v157
  v_and_b32 v123, 0xffff0000, v157
  v_cvt_pk_bf16_f32 v158, v124, v125
  v_lshlrev_b32 v124, 16, v158
  v_and_b32 v125, 0xffff0000, v158
  v_mul_f32 v124, s10, v124
  v_mul_f32 v125, s10, v125
  v_cvt_pk_bf16_f32 v158, v124, v125
  v_lshlrev_b32 v124, 16, v158
  v_and_b32 v125, 0xffff0000, v158
  v_cvt_pk_bf16_f32 v159, v126, v127
  v_lshlrev_b32 v126, 16, v159
  v_and_b32 v127, 0xffff0000, v159
  v_mul_f32 v126, s10, v126
  v_mul_f32 v127, s10, v127
  v_cvt_pk_bf16_f32 v159, v126, v127
  v_lshlrev_b32 v126, 16, v159
  v_and_b32 v127, 0xffff0000, v159
  v_cvt_pk_bf16_f32 v156, v128, v129
  v_lshlrev_b32 v128, 16, v156
  v_and_b32 v129, 0xffff0000, v156
  v_mul_f32 v128, s10, v128
  v_mul_f32 v129, s10, v129
  v_cvt_pk_bf16_f32 v156, v128, v129
  v_lshlrev_b32 v128, 16, v156
  v_and_b32 v129, 0xffff0000, v156
  v_cvt_pk_bf16_f32 v157, v130, v131
  v_lshlrev_b32 v130, 16, v157
  v_and_b32 v131, 0xffff0000, v157
  v_mul_f32 v130, s10, v130
  v_mul_f32 v131, s10, v131
  v_cvt_pk_bf16_f32 v157, v130, v131
  v_lshlrev_b32 v130, 16, v157
  v_and_b32 v131, 0xffff0000, v157
  v_cvt_pk_bf16_f32 v158, v132, v133
  v_lshlrev_b32 v132, 16, v158
  v_and_b32 v133, 0xffff0000, v158
  v_mul_f32 v132, s10, v132
  v_mul_f32 v133, s10, v133
  v_cvt_pk_bf16_f32 v158, v132, v133
  v_lshlrev_b32 v132, 16, v158
  v_and_b32 v133, 0xffff0000, v158
  v_cvt_pk_bf16_f32 v159, v134, v135
  v_lshlrev_b32 v134, 16, v159
  v_and_b32 v135, 0xffff0000, v159
  v_mul_f32 v134, s10, v134
  v_mul_f32 v135, s10, v135
  v_cvt_pk_bf16_f32 v159, v134, v135
  v_lshlrev_b32 v134, 16, v159
  v_and_b32 v135, 0xffff0000, v159
  v_max3_f32 v154, v104, v105, v106
  v_max3_f32 v154, v154, v107, v108
  v_max3_f32 v154, v154, v109, v110
  v_max3_f32 v154, v154, v111, v112
  v_max3_f32 v154, v154, v113, v114
  v_max3_f32 v154, v154, v115, v116
  v_max3_f32 v154, v154, v117, v118
  v_max3_f32 v154, v154, v119, v120
  v_max3_f32 v154, v154, v121, v122
  v_max3_f32 v154, v154, v123, v124
  v_max3_f32 v154, v154, v125, v126
  v_max3_f32 v154, v154, v127, v128
  v_max3_f32 v154, v154, v129, v130
  v_max3_f32 v154, v154, v131, v132
  v_max3_f32 v154, v154, v133, v134
  v_max_f32 v154, v154, v135
  v_mov_b32 v152, v154
  s_nop 1
  v_permlane16_swap_b32 v154, v152
  v_max_f32 v154, v154, v152
  v_mov_b32 v152, v154
  s_nop 1
  v_permlane32_swap_b32 v154, v152
  v_max_f32 v154, v154, v152
  v_sub_f32 v104, v104, v154
  v_sub_f32 v105, v105, v154
  v_sub_f32 v106, v106, v154
  v_sub_f32 v107, v107, v154
  v_mul_f32 v104, s11, v104
  v_mul_f32 v105, s11, v105
  v_mul_f32 v106, s11, v106
  v_mul_f32 v107, s11, v107
  v_exp_f32 v104, v104
  v_exp_f32 v105, v105
  v_exp_f32 v106, v106
  v_exp_f32 v107, v107
  v_sub_f32 v108, v108, v154
  v_sub_f32 v109, v109, v154
  v_sub_f32 v110, v110, v154
  v_sub_f32 v111, v111, v154
  v_mul_f32 v108, s11, v108
  v_mul_f32 v109, s11, v109
  v_mul_f32 v110, s11, v110
  v_mul_f32 v111, s11, v111
  v_exp_f32 v108, v108
  v_exp_f32 v109, v109
  v_exp_f32 v110, v110
  v_exp_f32 v111, v111
  v_sub_f32 v112, v112, v154
  v_sub_f32 v113, v113, v154
  v_sub_f32 v114, v114, v154
  v_sub_f32 v115, v115, v154
  v_mul_f32 v112, s11, v112
  v_mul_f32 v113, s11, v113
  v_mul_f32 v114, s11, v114
  v_mul_f32 v115, s11, v115
  v_exp_f32 v112, v112
  v_exp_f32 v113, v113
  v_exp_f32 v114, v114
  v_exp_f32 v115, v115
  v_sub_f32 v116, v116, v154
  v_sub_f32 v117, v117, v154
  v_sub_f32 v118, v118, v154
  v_sub_f32 v119, v119, v154
  v_mul_f32 v116, s11, v116
  v_mul_f32 v117, s11, v117
  v_mul_f32 v118, s11, v118
  v_mul_f32 v119, s11, v119
  v_exp_f32 v116, v116
  v_exp_f32 v117, v117
  v_exp_f32 v118, v118
  v_exp_f32 v119, v119
  v_sub_f32 v120, v120, v154
  v_sub_f32 v121, v121, v154
  v_sub_f32 v122, v122, v154
  v_sub_f32 v123, v123, v154
  v_mul_f32 v120, s11, v120
  v_mul_f32 v121, s11, v121
  v_mul_f32 v122, s11, v122
  v_mul_f32 v123, s11, v123
  v_exp_f32 v120, v120
  v_exp_f32 v121, v121
  v_exp_f32 v122, v122
  v_exp_f32 v123, v123
  v_sub_f32 v124, v124, v154
  v_sub_f32 v125, v125, v154
  v_sub_f32 v126, v126, v154
  v_sub_f32 v127, v127, v154
  v_mul_f32 v124, s11, v124
  v_mul_f32 v125, s11, v125
  v_mul_f32 v126, s11, v126
  v_mul_f32 v127, s11, v127
  v_exp_f32 v124, v124
  v_exp_f32 v125, v125
  v_exp_f32 v126, v126
  v_exp_f32 v127, v127
  v_sub_f32 v128, v128, v154
  v_sub_f32 v129, v129, v154
  v_sub_f32 v130, v130, v154
  v_sub_f32 v131, v131, v154
  v_mul_f32 v128, s11, v128
  v_mul_f32 v129, s11, v129
  v_mul_f32 v130, s11, v130
  v_mul_f32 v131, s11, v131
  v_exp_f32 v128, v128
  v_exp_f32 v129, v129
  v_exp_f32 v130, v130
  v_exp_f32 v131, v131
  v_sub_f32 v132, v132, v154
  v_sub_f32 v133, v133, v154
  v_sub_f32 v134, v134, v154
  v_sub_f32 v135, v135, v154
  v_mul_f32 v132, s11, v132
  v_mul_f32 v133, s11, v133
  v_mul_f32 v134, s11, v134
  v_mul_f32 v135, s11, v135
  v_exp_f32 v132, v132
  v_exp_f32 v133, v133
  v_exp_f32 v134, v134
  v_exp_f32 v135, v135
  v_add_f32 v155, v104, v105
  v_add_f32 v152, v106, v107
  v_add_f32 v155, v155, v108
  v_add_f32 v152, v152, v109
  v_add_f32 v155, v155, v110
  v_add_f32 v152, v152, v111
  v_add_f32 v155, v155, v112
  v_add_f32 v152, v152, v113
  v_add_f32 v155, v155, v114
  v_add_f32 v152, v152, v115
  v_add_f32 v155, v155, v116
  v_add_f32 v152, v152, v117
  v_add_f32 v155, v155, v118
  v_add_f32 v152, v152, v119
  v_add_f32 v155, v155, v120
  v_add_f32 v152, v152, v121
  v_add_f32 v155, v155, v122
  v_add_f32 v152, v152, v123
  v_add_f32 v155, v155, v124
  v_add_f32 v152, v152, v125
  v_add_f32 v155, v155, v126
  v_add_f32 v152, v152, v127
  v_add_f32 v155, v155, v128
  v_add_f32 v152, v152, v129
  v_add_f32 v155, v155, v130
  v_add_f32 v152, v152, v131
  v_add_f32 v155, v155, v132
  v_add_f32 v152, v152, v133
  v_add_f32 v155, v155, v134
  v_add_f32 v152, v152, v135
  v_add_f32 v155, v155, v152
  v_mov_b32 v152, v155
  s_nop 1
  v_permlane16_swap_b32 v155, v152
  v_add_f32 v155, v155, v152
  v_mov_b32 v152, v155
  s_nop 1
  v_permlane32_swap_b32 v155, v152
  v_add_f32 v155, v155, v152
  v_cvt_pk_bf16_f32 v136, v104, v105
  v_cvt_pk_bf16_f32 v137, v106, v107
  v_cvt_pk_bf16_f32 v138, v108, v109
  v_cvt_pk_bf16_f32 v139, v110, v111
  v_cvt_pk_bf16_f32 v140, v112, v113
  v_cvt_pk_bf16_f32 v141, v114, v115
  v_cvt_pk_bf16_f32 v142, v116, v117
  v_cvt_pk_bf16_f32 v143, v118, v119
  v_cvt_pk_bf16_f32 v144, v120, v121
  v_cvt_pk_bf16_f32 v145, v122, v123
  v_cvt_pk_bf16_f32 v146, v124, v125
  v_cvt_pk_bf16_f32 v147, v126, v127
  v_cvt_pk_bf16_f32 v148, v128, v129
  v_cvt_pk_bf16_f32 v149, v130, v131
  v_cvt_pk_bf16_f32 v150, v132, v133
  v_cvt_pk_bf16_f32 v151, v134, v135
  s_lshl_b32 s12, s4, 2
  v_lshlrev_b32 v152, 5, v3
  v_add_u32 v152, s12, v152
  ds_write_b32 v152, v154 offset:6400
  ds_write_b32 v152, v155 offset:6656
  v_mov_b32 v7, v154
  v_mov_b32 v152, 0
  v_mov_b32 v153, 1
  s_mov_b64 exec, 1
  ds_add_u32 v152, v153 offset:16
  s_mov_b64 exec, -1
  s_waitcnt vmcnt(16)
  v_perm_b32 v152, v76, v72, s8
  v_perm_b32 v156, v76, v72, s9
  v_perm_b32 v153, v84, v80, s8
  v_perm_b32 v157, v84, v80, s9
  v_perm_b32 v154, v92, v88, s8
  v_perm_b32 v158, v92, v88, s9
  v_perm_b32 v155, v100, v96, s8
  v_perm_b32 v159, v100, v96, s9
  s_nop 0
  v_mfma_f32_16x16x32_bf16 v[104:107], v[152:155], v[136:139], 0
  v_mfma_f32_16x16x32_bf16 v[108:111], v[156:159], v[136:139], 0
  v_perm_b32 v160, v77, v73, s8
  v_perm_b32 v164, v77, v73, s9
  v_perm_b32 v161, v85, v81, s8
  v_perm_b32 v165, v85, v81, s9
  v_perm_b32 v162, v93, v89, s8
  v_perm_b32 v166, v93, v89, s9
  v_perm_b32 v163, v101, v97, s8
  v_perm_b32 v167, v101, v97, s9
  s_nop 0
  v_mfma_f32_16x16x32_bf16 v[112:115], v[160:163], v[136:139], 0
  v_mfma_f32_16x16x32_bf16 v[116:119], v[164:167], v[136:139], 0
  v_perm_b32 v152, v78, v74, s8
  v_perm_b32 v156, v78, v74, s9
  v_perm_b32 v153, v86, v82, s8
  v_perm_b32 v157, v86, v82, s9
  v_perm_b32 v154, v94, v90, s8
  v_perm_b32 v158, v94, v90, s9
  v_perm_b32 v155, v102, v98, s8
  v_perm_b32 v159, v102, v98, s9
  s_nop 0
  v_mfma_f32_16x16x32_bf16 v[120:123], v[152:155], v[136:139], 0
  v_mfma_f32_16x16x32_bf16 v[124:127], v[156:159], v[136:139], 0
  v_perm_b32 v160, v79, v75, s8
  v_perm_b32 v164, v79, v75, s9
  v_perm_b32 v161, v87, v83, s8
  v_perm_b32 v165, v87, v83, s9
  v_perm_b32 v162, v95, v91, s8
  v_perm_b32 v166, v95, v91, s9
  v_perm_b32 v163, v103, v99, s8
  v_perm_b32 v167, v103, v99, s9
  s_nop 0
  v_mfma_f32_16x16x32_bf16 v[128:131], v[160:163], v[136:139], 0
  v_mfma_f32_16x16x32_bf16 v[132:135], v[164:167], v[136:139], 0
  s_waitcnt vmcnt(15)
  s_add_u32 s6, s5, 12582912
  buffer_load_dwordx4 v[72:75], v2, s[52:55], s6 offen offset:0 nt
  s_waitcnt vmcnt(15)
  s_add_u32 s6, s5, 12583936
  buffer_load_dwordx4 v[76:79], v2, s[52:55], s6 offen offset:0 nt
  s_waitcnt vmcnt(15)
  s_add_u32 s6, s5, 12584960
  buffer_load_dwordx4 v[80:83], v2, s[52:55], s6 offen offset:0 nt
  s_waitcnt vmcnt(15)
  s_add_u32 s6, s5, 12585984
  buffer_load_dwordx4 v[84:87], v2, s[52:55], s6 offen offset:0 nt
  s_waitcnt vmcnt(15)
  s_add_u32 s6, s5, 12587008
  buffer_load_dwordx4 v[88:91], v2, s[52:55], s6 offen offset:0 nt
  s_waitcnt vmcnt(15)
  s_add_u32 s6, s5, 12588032
  buffer_load_dwordx4 v[92:95], v2, s[52:55], s6 offen offset:0 nt
  s_waitcnt vmcnt(15)
  s_add_u32 s6, s5, 12589056
  buffer_load_dwordx4 v[96:99], v2, s[52:55], s6 offen offset:0 nt
  s_waitcnt vmcnt(15)
  s_add_u32 s6, s5, 12590080
  buffer_load_dwordx4 v[100:103], v2, s[52:55], s6 offen offset:0 nt
  v_mov_b32 v4, 0
  v_mov_b32 v5, 1
  s_mov_b64 exec, 1
  ds_add_u32 v4, v5 offset:36
  s_mov_b64 exec, -1
  s_waitcnt vmcnt(16)
  v_perm_b32 v152, v12, v8, s8
  v_perm_b32 v156, v12, v8, s9
  v_perm_b32 v153, v20, v16, s8
  v_perm_b32 v157, v20, v16, s9
  v_perm_b32 v154, v28, v24, s8
  v_perm_b32 v158, v28, v24, s9
  v_perm_b32 v155, v36, v32, s8
  v_perm_b32 v159, v36, v32, s9
  s_nop 0
  v_mfma_f32_16x16x32_bf16 v[104:107], v[152:155], v[140:143], v[104:107]
  v_mfma_f32_16x16x32_bf16 v[108:111], v[156:159], v[140:143], v[108:111]
  v_perm_b32 v160, v13, v9, s8
  v_perm_b32 v164, v13, v9, s9
  v_perm_b32 v161, v21, v17, s8
  v_perm_b32 v165, v21, v17, s9
  v_perm_b32 v162, v29, v25, s8
  v_perm_b32 v166, v29, v25, s9
  v_perm_b32 v163, v37, v33, s8
  v_perm_b32 v167, v37, v33, s9
  s_nop 0
  v_mfma_f32_16x16x32_bf16 v[112:115], v[160:163], v[140:143], v[112:115]
  v_mfma_f32_16x16x32_bf16 v[116:119], v[164:167], v[140:143], v[116:119]
  v_perm_b32 v152, v14, v10, s8
  v_perm_b32 v156, v14, v10, s9
  v_perm_b32 v153, v22, v18, s8
  v_perm_b32 v157, v22, v18, s9
  v_perm_b32 v154, v30, v26, s8
  v_perm_b32 v158, v30, v26, s9
  v_perm_b32 v155, v38, v34, s8
  v_perm_b32 v159, v38, v34, s9
  s_nop 0
  v_mfma_f32_16x16x32_bf16 v[120:123], v[152:155], v[140:143], v[120:123]
  v_mfma_f32_16x16x32_bf16 v[124:127], v[156:159], v[140:143], v[124:127]
  v_perm_b32 v160, v15, v11, s8
  v_perm_b32 v164, v15, v11, s9
  v_perm_b32 v161, v23, v19, s8
  v_perm_b32 v165, v23, v19, s9
  v_perm_b32 v162, v31, v27, s8
  v_perm_b32 v166, v31, v27, s9
  v_perm_b32 v163, v39, v35, s8
  v_perm_b32 v167, v39, v35, s9
  s_nop 0
  v_mfma_f32_16x16x32_bf16 v[128:131], v[160:163], v[140:143], v[128:131]
  v_mfma_f32_16x16x32_bf16 v[132:135], v[164:167], v[140:143], v[132:135]
  s_waitcnt vmcnt(8)
  v_perm_b32 v152, v44, v40, s8
  v_perm_b32 v156, v44, v40, s9
  v_perm_b32 v153, v52, v48, s8
  v_perm_b32 v157, v52, v48, s9
  v_perm_b32 v154, v60, v56, s8
  v_perm_b32 v158, v60, v56, s9
  v_perm_b32 v155, v68, v64, s8
  v_perm_b32 v159, v68, v64, s9
  s_nop 0
  v_mfma_f32_16x16x32_bf16 v[104:107], v[152:155], v[144:147], v[104:107]
  v_mfma_f32_16x16x32_bf16 v[108:111], v[156:159], v[144:147], v[108:111]
  v_perm_b32 v160, v45, v41, s8
  v_perm_b32 v164, v45, v41, s9
  v_perm_b32 v161, v53, v49, s8
  v_perm_b32 v165, v53, v49, s9
  v_perm_b32 v162, v61, v57, s8
  v_perm_b32 v166, v61, v57, s9
  v_perm_b32 v163, v69, v65, s8
  v_perm_b32 v167, v69, v65, s9
  s_nop 0
  v_mfma_f32_16x16x32_bf16 v[112:115], v[160:163], v[144:147], v[112:115]
  v_mfma_f32_16x16x32_bf16 v[116:119], v[164:167], v[144:147], v[116:119]
  v_perm_b32 v152, v46, v42, s8
  v_perm_b32 v156, v46, v42, s9
  v_perm_b32 v153, v54, v50, s8
  v_perm_b32 v157, v54, v50, s9
  v_perm_b32 v154, v62, v58, s8
  v_perm_b32 v158, v62, v58, s9
  v_perm_b32 v155, v70, v66, s8
  v_perm_b32 v159, v70, v66, s9
  s_nop 0
  v_mfma_f32_16x16x32_bf16 v[120:123], v[152:155], v[144:147], v[120:123]
  v_mfma_f32_16x16x32_bf16 v[124:127], v[156:159], v[144:147], v[124:127]
  v_perm_b32 v160, v47, v43, s8
  v_perm_b32 v164, v47, v43, s9
  v_perm_b32 v161, v55, v51, s8
  v_perm_b32 v165, v55, v51, s9
  v_perm_b32 v162, v63, v59, s8
  v_perm_b32 v166, v63, v59, s9
  v_perm_b32 v163, v71, v67, s8
  v_perm_b32 v167, v71, v67, s9
  s_nop 0
  v_mfma_f32_16x16x32_bf16 v[128:131], v[160:163], v[144:147], v[128:131]
  v_mfma_f32_16x16x32_bf16 v[132:135], v[164:167], v[144:147], v[132:135]
  s_mov_b32 s14, 65536
  v_mov_b32 v4, 0
L_swf_49:
  ds_read_b32 v5, v4 offset:16
  s_waitcnt lgkmcnt(0)
  v_readfirstlane_b32 s15, v5
  s_nop 0
  s_cmp_ge_u32 s15, 8
  s_cbranch_scc1 L_swxf_50
  s_sleep 2
  s_sub_u32 s14, s14, 1
  s_cmp_eq_u32 s14, 0
  s_cbranch_scc0 L_swf_49
L_swxf_50:
  v_lshlrev_b32 v4, 5, v3
  ds_read_b128 v[136:139], v4 offset:6400
  ds_read_b128 v[140:143], v4 offset:6416
  v_lshrrev_b32 v5, 4, v0
  v_lshl_add_u32 v5, v3, 2, v5
  v_lshlrev_b32 v5, 4, v5
  v_add_u32 v5, s7, v5
  s_waitcnt lgkmcnt(0)
  v_max3_f32 v136, v136, v137, v138
  v_max3_f32 v140, v139, v140, v141
  v_max3_f32 v136, v136, v142, v143
  v_max_f32 v136, v136, v140
  v_sub_f32 v6, v7, v136
  v_mul_f32 v6, s11, v6
  v_exp_f32 v6, v6
  s_waitcnt vmcnt(0)
  v_perm_b32 v152, v76, v72, s8
  v_perm_b32 v156, v76, v72, s9
  v_perm_b32 v153, v84, v80, s8
  v_perm_b32 v157, v84, v80, s9
  v_perm_b32 v154, v92, v88, s8
  v_perm_b32 v158, v92, v88, s9
  v_perm_b32 v155, v100, v96, s8
  v_perm_b32 v159, v100, v96, s9
  s_nop 0
  v_mfma_f32_16x16x32_bf16 v[104:107], v[152:155], v[148:151], v[104:107]
  v_mfma_f32_16x16x32_bf16 v[108:111], v[156:159], v[148:151], v[108:111]
  v_perm_b32 v160, v77, v73, s8
  v_perm_b32 v164, v77, v73, s9
  v_perm_b32 v161, v85, v81, s8
  v_perm_b32 v165, v85, v81, s9
  v_perm_b32 v162, v93, v89, s8
  v_perm_b32 v166, v93, v89, s9
  v_perm_b32 v163, v101, v97, s8
  v_perm_b32 v167, v101, v97, s9
  s_nop 0
  v_mfma_f32_16x16x32_bf16 v[112:115], v[160:163], v[148:151], v[112:115]
  v_mfma_f32_16x16x32_bf16 v[116:119], v[164:167], v[148:151], v[116:119]
  v_perm_b32 v152, v78, v74, s8
  v_perm_b32 v156, v78, v74, s9
  v_perm_b32 v153, v86, v82, s8
  v_perm_b32 v157, v86, v82, s9
  v_perm_b32 v154, v94, v90, s8
  v_perm_b32 v158, v94, v90, s9
  v_perm_b32 v155, v102, v98, s8
  v_perm_b32 v159, v102, v98, s9
  s_nop 0
  v_mfma_f32_16x16x32_bf16 v[120:123], v[152:155], v[148:151], v[120:123]
  v_mfma_f32_16x16x32_bf16 v[124:127], v[156:159], v[148:151], v[124:127]
  v_perm_b32 v160, v79, v75, s8
  v_perm_b32 v164, v79, v75, s9
  v_perm_b32 v161, v87, v83, s8
  v_perm_b32 v165, v87, v83, s9
  v_perm_b32 v162, v95, v91, s8
  v_perm_b32 v166, v95, v91, s9
  v_perm_b32 v163, v103, v99, s8
  v_perm_b32 v167, v103, v99, s9
  s_nop 0
  v_mfma_f32_16x16x32_bf16 v[128:131], v[160:163], v[148:151], v[128:131]
  v_mfma_f32_16x16x32_bf16 v[132:135], v[164:167], v[148:151], v[132:135]
  v_pk_mul_f32 v[104:105], v[104:105], v[6:7] op_sel_hi:[1,0]
  v_pk_mul_f32 v[106:107], v[106:107], v[6:7] op_sel_hi:[1,0]
  ds_write_b128 v5, v[104:107] offset:0
  v_pk_mul_f32 v[108:109], v[108:109], v[6:7] op_sel_hi:[1,0]
  v_pk_mul_f32 v[110:111], v[110:111], v[6:7] op_sel_hi:[1,0]
  ds_write_b128 v5, v[108:111] offset:512
  v_pk_mul_f32 v[112:113], v[112:113], v[6:7] op_sel_hi:[1,0]
  v_pk_mul_f32 v[114:115], v[114:115], v[6:7] op_sel_hi:[1,0]
  ds_write_b128 v5, v[112:115] offset:1024
  v_pk_mul_f32 v[116:117], v[116:117], v[6:7] op_sel_hi:[1,0]
  v_pk_mul_f32 v[118:119], v[118:119], v[6:7] op_sel_hi:[1,0]
  ds_write_b128 v5, v[116:119] offset:1536
  v_pk_mul_f32 v[120:121], v[120:121], v[6:7] op_sel_hi:[1,0]
  v_pk_mul_f32 v[122:123], v[122:123], v[6:7] op_sel_hi:[1,0]
  ds_write_b128 v5, v[120:123] offset:2048
  v_pk_mul_f32 v[124:125], v[124:125], v[6:7] op_sel_hi:[1,0]
  v_pk_mul_f32 v[126:127], v[126:127], v[6:7] op_sel_hi:[1,0]
  ds_write_b128 v5, v[124:127] offset:2560
  v_pk_mul_f32 v[128:129], v[128:129], v[6:7] op_sel_hi:[1,0]
  v_pk_mul_f32 v[130:131], v[130:131], v[6:7] op_sel_hi:[1,0]
  ds_write_b128 v5, v[128:131] offset:3072
  v_pk_mul_f32 v[132:133], v[132:133], v[6:7] op_sel_hi:[1,0]
  v_pk_mul_f32 v[134:135], v[134:135], v[6:7] op_sel_hi:[1,0]
  ds_write_b128 v5, v[132:135] offset:3584
  s_waitcnt lgkmcnt(0)
  s_barrier
L_end:
  s_endpgm
L_codeend:
.section .rodata,"a"
.p2align 6
.amdhsa_kernel adaLN_cond__gqa_block_cached__mixer_channel_mlp__decode_kernel
  .amdhsa_next_free_vgpr 168
  .amdhsa_next_free_sgpr 102
  .amdhsa_accum_offset 168
  .amdhsa_group_segment_fixed_size 0
  .amdhsa_kernarg_size 120
  .amdhsa_user_sgpr_count 2
  .amdhsa_user_sgpr_kernarg_segment_ptr 1
  .amdhsa_system_sgpr_workgroup_id_x 1
.end_amdhsa_kernel
```
